```python
import torch

def _softmax(x, axis=-1):
    return torch.softmax(x, dim=axis)
def _gelu(x):
    return torch.nn.functional.gelu(x, approximate="tanh")
def _silu(x):
    return torch.nn.functional.silu(x)
def _sigmoid(x):
    return torch.sigmoid(x)
def _layernorm(x, axis=-1, eps=1e-5):
    m = x.mean(dim=axis, keepdim=True)
    v = x.var(dim=axis, keepdim=True, unbiased=False)
    return (x - m) / torch.sqrt(v + eps)
def _scatter_add(tgt, idx, src, axis=0):
    return tgt.clone().index_add_(axis, idx, src)
def _segment_sum(src, seg, n):
    out = torch.zeros((n,) + src.shape[1:], dtype=src.dtype)
    return out.index_add_(0, seg, src)
def _pad(x, pw):
    flat = tuple(v for pair in reversed(pw) for v in pair)
    return torch.nn.functional.pad(x, flat)

kernel_name = 'sequential_preLN__spectral_fnet__moe_arch_mod__prompt'

def setup_inputs():

    _w = (lambda a: (lambda t: t.to(torch.bfloat16) if t.is_floating_point() else t)(torch.as_tensor(a)))
    def _A_setup():
        B, S, D = 1, 2048, 448
        ns = torch.arange(S)[:, None] * torch.arange(S)[None, :]
        nd = torch.arange(D)[:, None] * torch.arange(D)[None, :]
        Ws_re = torch.cos(-2.0 * torch.pi * ns / S).to(float)
        Ws_im = torch.sin(-2.0 * torch.pi * ns / S).to(float)
        Wd_re = torch.cos(-2.0 * torch.pi * nd / D).to(float)
        Wd_im = torch.sin(-2.0 * torch.pi * nd / D).to(float)
        return {
            "x": _w((lambda *s: torch.randn(*s, dtype=torch.bfloat16) * 0.05)(B, S, D)),
            "dft_seq_re": _w(Ws_re),
            "dft_seq_im": _w(Ws_im),
            "dft_hid_re": _w(Wd_re),
            "dft_hid_im": _w(Wd_im),
        }
    _A_in = _A_setup()

    def _B_setup():
        B, S, D, F, C = 1, 2048, 448, 1792, 8
        return {
            "x": _w((lambda *s: torch.randn(*s, dtype=torch.bfloat16) * 0.05)(B, S, D)),
            "w_r": _w((lambda *s: torch.randn(*s, dtype=torch.bfloat16) * 1.6)(D)),
            "w_gate": _w((lambda *s: torch.randn(*s, dtype=torch.bfloat16) * 0.4)(D, F)),
            "w_up": _w((lambda *s: torch.randn(*s, dtype=torch.bfloat16) * 0.4)(D, F)),
            "w_down": _w((lambda *s: torch.randn(*s, dtype=torch.bfloat16) * 0.4)(F, D)),
        }
    _B_in = _B_setup()

    return {
        "A_x": _A_in["x"],
        "A_dft_seq_re": _A_in["dft_seq_re"],
        "A_dft_seq_im": _A_in["dft_seq_im"],
        "A_dft_hid_re": _A_in["dft_hid_re"],
        "A_dft_hid_im": _A_in["dft_hid_im"],
        "B_x": _B_in["x"],
        "B_w_r": _B_in["w_r"],
        "B_w_gate": _B_in["w_gate"],
        "B_w_up": _B_in["w_up"],
        "B_w_down": _B_in["w_down"],
    }

def reference(A_x, A_dft_seq_re, A_dft_seq_im, A_dft_hid_re, A_dft_hid_im, B_x, B_w_r, B_w_gate, B_w_up, B_w_down):
    def _A_ref(x, dft_seq_re, dft_seq_im, dft_hid_re, dft_hid_im):
        a = torch.einsum("bsd,ed->bse", x, dft_hid_re)
        b = torch.einsum("bsd,ed->bse", x, dft_hid_im)
        y = torch.einsum("ts,bse->bte", dft_seq_re, a) - torch.einsum("ts,bse->bte", dft_seq_im, b)
        return y

    def _B_ref(x, w_r, w_gate, w_up, w_down):
        B, S, D = x.shape
        C = 8
        r = x @ w_r
        idx = torch.argsort(-r, axis=-1)[:, :C]
        idx_e = (lambda x, n, axis: torch.repeat_interleave(x, n, dim=axis))(idx.reshape(B, C, 1), D, axis=2)
        x_sel = (lambda x, i, axis: torch.take_along_dim(x, i, dim=axis))(x, idx_e, axis=1)
        g = _silu(x_sel @ w_gate)
        u = x_sel @ w_up
        y = (g * u) @ w_down
        r_sel = _sigmoid((lambda x, i, axis: torch.take_along_dim(x, i, dim=axis))(r, idx, axis=1))
        y = y * r_sel.reshape(B, C, 1)
        b_off = (torch.arange(B) * S).reshape(B, 1)
        flat_idx = (idx + b_off).reshape(B * C)
        zero = (x * 0.0).reshape(B * S, D)
        upd = _scatter_add(zero, flat_idx, y.reshape(B * C, D), axis=0)
        return x + upd.reshape(B, S, D)

    x = A_x
    h = x + _A_ref(_layernorm(x, axis=-1), A_dft_seq_re, A_dft_seq_im, A_dft_hid_re, A_dft_hid_im)
    h2 = h + _B_ref(_layernorm(h, axis=-1), B_w_r, B_w_gate, B_w_up, B_w_down)
    return h2
```

```asm
; @launch grid=(256,1,1) block=(512,1,1) lds=156432
.amdgcn_target "amdgcn-amd-amdhsa--gfx950"
.text
.globl sequential_preLN__spectral_fnet__moe_arch_mod__prompt_kernel
.p2align 8
.type sequential_preLN__spectral_fnet__moe_arch_mod__prompt_kernel,@function
sequential_preLN__spectral_fnet__moe_arch_mod__prompt_kernel:
    v_readfirstlane_b32 s20, v0
    s_cmp_ge_u32 s2, 256
    s_cbranch_scc1 Lexit
    s_cmp_lt_u32 s20, 256
    s_cbranch_scc1 Lloader
    s_getpc_b64 s[30:31]
Lpc:
    v_and_b32 v6, 255, v0
    v_lshlrev_b32 v228, 7, v6
    v_mov_b32 v229, s31
    v_add_co_u32 v228, vcc, s30, v228
    s_nop 1
    v_addc_co_u32 v229, vcc, 0, v229, vcc
    v_cmp_gt_u32 vcc, (Lexit-Lpc)/128+1, v6
    s_and_saveexec_b64 s[30:31], vcc
    s_cbranch_execz Lpfd
    global_load_dword v230, v[228:229], off
Lpfd:
    s_branch Lcompute
Lloader:
    s_load_dwordx2 s[8:9], s[0:1], 0
    s_lshr_b32 s20, s20, 6
    v_and_b32 v1, 63, v0
    v_lshlrev_b32 v7, 4, v1
    s_and_b32 s21, s2, 31
    s_lshr_b32 s22, s2, 5
    s_mov_b32 s10, 1835008
    s_mov_b32 s11, 0x00020000
    v_cmp_lt_u32 vcc, 29, v1
    s_lshl_b32 s23, s20, 9
    s_add_u32 s23, s23, s21
    s_mul_i32 s23, s23, 896
    s_mul_i32 s24, s20, 7680
    v_add_u32 v5, 28192, v7
    s_mov_b32 s25, s22
    v_cndmask_b32 v5, v7, v5, vcc
    s_mov_b32 exec_lo, 0xcfffffff
    s_mov_b32 exec_hi, 0x03ffffff
    s_mov_b32 s28, 0
    s_waitcnt lgkmcnt(0)
Ldma:
    s_mul_i32 s26, s25, 960
    s_mul_i32 s27, s25, 57344
    s_add_u32 m0, s26, s24
    s_add_u32 s27, s27, s23
    s_add_u32 s25, s25, 1
    buffer_load_dwordx4 v5, s[8:11], s27 offen lds
    s_and_b32 s25, s25, 7
    s_mul_i32 s26, s25, 960
    s_mul_i32 s27, s25, 57344
    s_add_u32 m0, s26, s24
    s_add_u32 s27, s27, s23
    s_add_u32 s25, s25, 1
    buffer_load_dwordx4 v5, s[8:11], s27 offen lds
    s_and_b32 s25, s25, 7
    s_mul_i32 s26, s25, 960
    s_mul_i32 s27, s25, 57344
    s_add_u32 m0, s26, s24
    s_add_u32 s27, s27, s23
    s_add_u32 s25, s25, 1
    buffer_load_dwordx4 v5, s[8:11], s27 offen lds
    s_and_b32 s25, s25, 7
    s_mul_i32 s26, s25, 960
    s_mul_i32 s27, s25, 57344
    s_add_u32 m0, s26, s24
    s_add_u32 s27, s27, s23
    s_add_u32 s25, s25, 1
    buffer_load_dwordx4 v5, s[8:11], s27 offen lds
    s_and_b32 s25, s25, 7
    s_mul_i32 s26, s25, 960
    s_mul_i32 s27, s25, 57344
    s_add_u32 m0, s26, s24
    s_add_u32 s27, s27, s23
    s_add_u32 s25, s25, 1
    buffer_load_dwordx4 v5, s[8:11], s27 offen lds
    s_and_b32 s25, s25, 7
    s_mul_i32 s26, s25, 960
    s_mul_i32 s27, s25, 57344
    s_add_u32 m0, s26, s24
    s_add_u32 s27, s27, s23
    s_add_u32 s25, s25, 1
    buffer_load_dwordx4 v5, s[8:11], s27 offen lds
    s_and_b32 s25, s25, 7
    s_mul_i32 s26, s25, 960
    s_mul_i32 s27, s25, 57344
    s_add_u32 m0, s26, s24
    s_add_u32 s27, s27, s23
    s_add_u32 s25, s25, 1
    buffer_load_dwordx4 v5, s[8:11], s27 offen lds
    s_and_b32 s25, s25, 7
    s_mul_i32 s26, s25, 960
    s_mul_i32 s27, s25, 57344
    s_add_u32 m0, s26, s24
    s_add_u32 s27, s27, s23
    s_add_u32 s25, s25, 1
    buffer_load_dwordx4 v5, s[8:11], s27 offen lds
    s_and_b32 s25, s25, 7
    s_add_u32 s24, s24, 30720
    s_add_u32 s23, s23, 448
    s_add_u32 s28, s28, 1
    s_cmp_lt_u32 s28, 2
    s_cbranch_scc1 Ldma
    s_branch Lltail
Lcompute:
    s_mov_b64 exec, -1
    s_load_dwordx2 s[8:9], s[0:1], 0
    s_lshr_b32 s20, s20, 6
    v_and_b32 v1, 63, v0
    v_lshlrev_b32 v7, 4, v1
    s_and_b32 s21, s2, 31
    s_lshr_b32 s22, s2, 5
    s_mov_b32 s10, 1835008
    s_mov_b32 s11, 0x00020000
    s_load_dwordx2 s[6:7], s[0:1], 96
    s_load_dwordx8 s[40:47], s[0:1], 48
    s_load_dwordx2 s[48:49], s[0:1], 80
    v_and_b32 v2, 15, v0
    v_bfe_u32 v3, v0, 4, 2
    s_and_b32 s3, s20, 3
    s_setprio 3
    s_and_b32 s25, s3, 1
    s_lshl_b32 s25, s25, 2
    v_and_b32 v4, 3, v2
    v_add_u32 v4, s25, v4
    v_lshrrev_b32 v5, 2, v2
    s_mul_i32 s26, s22, 28
    s_add_u32 s26, s26, 1
    v_mad_u32_u24 v5, v5, 7, v4
    v_add_u32 v5, s26, v5
    v_cmp_ne_u32 vcc, 7, v4
    s_lshr_b32 s25, s3, 1
    s_mul_i32 s25, s25, 0x3e800000
    v_cndmask_b32 v5, 0, v5, vcc
    v_cvt_f32_u32 v5, v5
    v_mul_f32 v26, 0x3b124925, v5
    v_lshlrev_b32 v4, 3, v3
    v_cvt_f32_u32 v6, v4
    v_fma_f32 v27, v6, v26, s25
    s_mul_i32 s25, s3, 7168
    s_add_u32 s25, s25, 61440
    v_add_u32 v5, s25, v7
    v_mov_b32 v96, 0x3f803f80
    v_mov_b32 v97, 0x3f803f80
    v_mov_b32 v98, 0x3f803f80
    v_mov_b32 v99, 0x3f803f80
    v_cos_f32 v25, v26
    v_mov_b32 v116, v27
    v_fmamk_f32 v117, v26, 0x3f800000, v27
    v_fmamk_f32 v124, v26, 0x42000000, v27
    v_fmamk_f32 v125, v26, 0x42040000, v27
    v_fmamk_f32 v132, v26, 0x42800000, v27
    v_fmamk_f32 v133, v26, 0x42820000, v27
    v_fmamk_f32 v140, v26, 0x42c00000, v27
    v_fmamk_f32 v141, v26, 0x42c20000, v27
    v_fmamk_f32 v148, v26, 0x43000000, v27
    v_fmamk_f32 v149, v26, 0x43010000, v27
    v_fmamk_f32 v156, v26, 0x43200000, v27
    v_fmamk_f32 v157, v26, 0x43210000, v27
    v_fmamk_f32 v164, v26, 0x43400000, v27
    v_fmamk_f32 v165, v26, 0x43410000, v27
    v_add_f32 v25, v25, v25
    v_cos_f32 v116, v116
    v_cos_f32 v117, v117
    v_cos_f32 v124, v124
    v_cos_f32 v125, v125
    v_cos_f32 v132, v132
    v_cos_f32 v133, v133
    v_cos_f32 v140, v140
    v_cos_f32 v141, v141
    v_cos_f32 v148, v148
    v_cos_f32 v149, v149
    v_cos_f32 v156, v156
    v_cos_f32 v157, v157
    v_cos_f32 v164, v164
    v_cos_f32 v165, v165
    v_fma_f32 v118, v25, v117, -v116
    v_fma_f32 v126, v25, v125, -v124
    v_fma_f32 v134, v25, v133, -v132
    v_fma_f32 v142, v25, v141, -v140
    v_fma_f32 v150, v25, v149, -v148
    v_fma_f32 v158, v25, v157, -v156
    v_fma_f32 v166, v25, v165, -v164
    v_fma_f32 v119, v25, v118, -v117
    v_fma_f32 v127, v25, v126, -v125
    v_fma_f32 v135, v25, v134, -v133
    v_fma_f32 v143, v25, v142, -v141
    v_fma_f32 v151, v25, v150, -v149
    v_fma_f32 v159, v25, v158, -v157
    v_fma_f32 v167, v25, v166, -v165
    v_fma_f32 v120, v25, v119, -v118
    v_fma_f32 v128, v25, v127, -v126
    v_fma_f32 v136, v25, v135, -v134
    v_fma_f32 v144, v25, v143, -v142
    v_fma_f32 v152, v25, v151, -v150
    v_fma_f32 v160, v25, v159, -v158
    v_fma_f32 v168, v25, v167, -v166
    v_fma_f32 v121, v25, v120, -v119
    v_fma_f32 v129, v25, v128, -v127
    v_fma_f32 v137, v25, v136, -v135
    v_fma_f32 v145, v25, v144, -v143
    v_fma_f32 v153, v25, v152, -v151
    v_fma_f32 v161, v25, v160, -v159
    v_fma_f32 v169, v25, v168, -v167
    v_fma_f32 v122, v25, v121, -v120
    v_fma_f32 v130, v25, v129, -v128
    v_fma_f32 v138, v25, v137, -v136
    v_fma_f32 v146, v25, v145, -v144
    v_fma_f32 v154, v25, v153, -v152
    v_fma_f32 v162, v25, v161, -v160
    v_fma_f32 v170, v25, v169, -v168
    v_fma_f32 v123, v25, v122, -v121
    v_fma_f32 v131, v25, v130, -v129
    v_fma_f32 v139, v25, v138, -v137
    v_fma_f32 v147, v25, v146, -v145
    v_fma_f32 v155, v25, v154, -v153
    v_fma_f32 v163, v25, v162, -v161
    v_fma_f32 v171, v25, v170, -v169
    v_cvt_pk_bf16_f32 v172, v116, v117
    v_cvt_pk_bf16_f32 v173, v118, v119
    v_cvt_pk_bf16_f32 v174, v120, v121
    v_cvt_pk_bf16_f32 v175, v122, v123
    ds_write_b128 v5, v[172:175] offset:0
    s_nop 0
    v_mfma_f32_16x16x32_bf16 v[52:55], v[172:175], v[96:99], 0
    v_cvt_pk_bf16_f32 v176, v124, v125
    v_cvt_pk_bf16_f32 v177, v126, v127
    v_cvt_pk_bf16_f32 v178, v128, v129
    v_cvt_pk_bf16_f32 v179, v130, v131
    ds_write_b128 v5, v[176:179] offset:1024
    s_nop 0
    v_mfma_f32_16x16x32_bf16 v[52:55], v[176:179], v[96:99], v[52:55]
    v_cvt_pk_bf16_f32 v180, v132, v133
    v_cvt_pk_bf16_f32 v181, v134, v135
    v_cvt_pk_bf16_f32 v182, v136, v137
    v_cvt_pk_bf16_f32 v183, v138, v139
    ds_write_b128 v5, v[180:183] offset:2048
    s_nop 0
    v_mfma_f32_16x16x32_bf16 v[52:55], v[180:183], v[96:99], v[52:55]
    v_cvt_pk_bf16_f32 v184, v140, v141
    v_cvt_pk_bf16_f32 v185, v142, v143
    v_cvt_pk_bf16_f32 v186, v144, v145
    v_cvt_pk_bf16_f32 v187, v146, v147
    ds_write_b128 v5, v[184:187] offset:3072
    s_nop 0
    v_mfma_f32_16x16x32_bf16 v[52:55], v[184:187], v[96:99], v[52:55]
    v_cvt_pk_bf16_f32 v188, v148, v149
    v_cvt_pk_bf16_f32 v189, v150, v151
    v_cvt_pk_bf16_f32 v190, v152, v153
    v_cvt_pk_bf16_f32 v191, v154, v155
    ds_write_b128 v5, v[188:191] offset:4096
    s_nop 0
    v_mfma_f32_16x16x32_bf16 v[52:55], v[188:191], v[96:99], v[52:55]
    v_cvt_pk_bf16_f32 v192, v156, v157
    v_cvt_pk_bf16_f32 v193, v158, v159
    v_cvt_pk_bf16_f32 v194, v160, v161
    v_cvt_pk_bf16_f32 v195, v162, v163
    ds_write_b128 v5, v[192:195] offset:5120
    s_nop 0
    v_mfma_f32_16x16x32_bf16 v[52:55], v[192:195], v[96:99], v[52:55]
    v_cvt_pk_bf16_f32 v196, v164, v165
    v_cvt_pk_bf16_f32 v197, v166, v167
    v_cvt_pk_bf16_f32 v198, v168, v169
    v_cvt_pk_bf16_f32 v199, v170, v171
    ds_write_b128 v5, v[196:199] offset:6144
    s_nop 0
    v_mfma_f32_16x16x32_bf16 v[52:55], v[196:199], v[96:99], v[52:55]
    v_lshrrev_b32 v22, 1, v2
    s_lshl_b32 s25, s3, 3
    v_add_u32 v22, s25, v22
    v_and_b32 v24, 1, v2
    v_lshlrev_b32 v21, 16, v22
    v_lshl_add_u32 v21, v24, 6, v21
    v_lshl_add_u32 v21, v3, 4, v21
    s_lshl_b32 s25, s3, 6
    v_lshlrev_b32 v4, 4, v3
    v_add_u32 v20, 90112, v4
    v_add_u32 v5, s25, v20
    v_lshlrev_b32 v233, 31, v3
    v_or_b32 v233, 1.0, v233
    v_xor_b32 v232, 0x80000000, v233
    v_pk_fma_f32 v[52:53], v[52:53], v[232:233], v[52:53]
    v_pk_fma_f32 v[54:55], v[54:55], v[232:233], v[54:55]
    ds_write_b128 v5, v[52:55]
    v_lshrrev_b32 v22, 1, v2
    s_lshl_b32 s25, s3, 3
    v_add_u32 v22, s25, v22
    v_sub_u32 v23, 64, v22
    v_cmp_eq_u32 vcc, 0, v22
    v_and_b32 v24, 1, v2
    s_nop 0
    v_cndmask_b32 v23, v23, 32, vcc
    v_cmp_eq_u32 vcc, 0, v24
    v_lshlrev_b32 v24, 3, v3
    s_nop 0
    v_cndmask_b32 v23, v23, v22, vcc
    v_cvt_f32_u32 v24, v24
    v_and_b32 v22, 1, v23
    v_cvt_f32_u32 v23, v23
    v_mul_u32_u24 v22, 0x8000, v22
    v_mul_f32 v26, 0x3c800000, v23
    v_lshl_or_b32 v22, v22, 16, v22
    v_mul_f32 v27, v24, v26
    v_cos_f32 v25, v26
    v_add_f32 v89, v26, v27
    v_sin_f32 v96, v27
    v_cos_f32 v88, v27
    v_sin_f32 v97, v89
    v_cos_f32 v89, v89
    v_add_f32 v25, v25, v25
    v_fma_f32 v90, v25, v89, -v88
    v_fma_f32 v98, v25, v97, -v96
    v_fma_f32 v91, v25, v90, -v89
    v_fma_f32 v99, v25, v98, -v97
    v_fma_f32 v92, v25, v91, -v90
    v_fma_f32 v100, v25, v99, -v98
    v_fma_f32 v93, v25, v92, -v91
    v_fma_f32 v101, v25, v100, -v99
    v_fma_f32 v94, v25, v93, -v92
    v_fma_f32 v102, v25, v101, -v100
    v_fma_f32 v95, v25, v94, -v93
    v_fma_f32 v103, v25, v102, -v101
    v_cvt_pk_f16_f32 v28, v88, v89
    v_cvt_pk_f16_f32 v36, v96, v97
    v_cvt_pk_f16_f32 v29, v90, v91
    v_cvt_pk_f16_f32 v37, v98, v99
    v_cvt_pk_f16_f32 v30, v92, v93
    v_cvt_pk_f16_f32 v38, v100, v101
    v_cvt_pk_f16_f32 v31, v94, v95
    v_cvt_pk_f16_f32 v39, v102, v103
    v_xor_b32 v32, v22, v28
    v_xor_b32 v40, v22, v36
    v_xor_b32 v33, v22, v29
    v_xor_b32 v41, v22, v37
    v_xor_b32 v34, v22, v30
    v_xor_b32 v42, v22, v38
    v_xor_b32 v35, v22, v31
    v_xor_b32 v43, v22, v39
    v_xor_b32 v44, 0x80008000, v36
    v_xor_b32 v45, 0x80008000, v37
    v_xor_b32 v46, 0x80008000, v38
    v_xor_b32 v47, 0x80008000, v39
    v_xor_b32 v48, 0x80008000, v40
    v_xor_b32 v49, 0x80008000, v41
    v_xor_b32 v50, 0x80008000, v42
    v_xor_b32 v51, 0x80008000, v43
    v_add_u32 v6, 61440, v7
    s_lshl_b32 s25, s3, 4
    v_add_u32 v22, s25, v2
    v_mul_u32_u24 v19, 480, v22
    v_add_u32 v19, v4, v19
    v_mul_u32_u24 v17, 136, v22
    v_lshl_add_u32 v17, v3, 3, v17
    v_add_u32 v17, 90384, v17
    v_lshrrev_b32 v22, 2, v2
    v_lshl_add_u32 v22, v3, 3, v22
    v_mul_u32_u24 v18, 136, v22
    v_and_b32 v22, 3, v2
    v_lshl_add_u32 v18, v22, 3, v18
    v_add_u32 v18, 90384, v18
    s_lshl_b32 s23, s21, 11
    s_lshl_b32 s24, s22, 8
    s_add_u32 s23, s23, s24
    s_mov_b32 s30, 0x100001
    s_mov_b32 s31, 0x10000100
    s_mov_b32 s32, 0x200002
    s_mov_b32 s33, 0x20000200
    s_mov_b32 s34, 0x400004
    s_mov_b32 s35, 0x40000400
    s_mov_b32 s36, 0x800008
    s_mov_b32 s37, 0x80000800
    s_mov_b64 s[24:25], 0xffff
    s_mov_b32 s38, 0
    s_cmp_eq_u32 s22, 7
    s_cselect_b32 s39, 0xffff0000, 0
    s_waitcnt lgkmcnt(0)
    s_mov_b32 s12, s6
    s_and_b32 s13, s7, 0xffff
    s_mov_b32 s14, 8388608
    s_mov_b32 s15, 0x00020000
    s_mov_b32 s52, s48
    s_and_b32 s53, s49, 0xffff
    s_mov_b32 s54, 1835008
    s_mov_b32 s55, 0x00020000
    s_mov_b32 s16, s40
    s_and_b32 s17, s41, 0xffff
    s_mov_b32 s18, 896
    s_mov_b32 s19, 0x00020000
    s_and_b32 s92, s2, 7
    s_lshr_b32 s93, s2, 6
    s_lshl_b32 s93, s93, 3
    s_or_b32 s92, s92, s93
    s_bfe_u32 s93, s2, 0x10003
    s_bfe_u32 s96, s2, 0x20004
    s_sub_u32 s95, 64, s92
    s_cmp_eq_u32 s92, 0
    s_cselect_b32 s95, 32, s95
    s_cselect_b32 s94, 0, 1
    s_xor_b32 s94, s94, s93
    s_cmp_eq_u32 s93, 0
    s_cselect_b32 s95, s92, s95
    s_lshl_b32 s96, s96, 9
    s_add_u32 s95, s95, s96
    s_lshl_b32 s96, s20, 6
    s_add_u32 s96, s96, s95
    s_mul_i32 s97, s96, 896
    s_barrier
    ds_read_b128 v[88:91], v19 offset:0
    ds_read_b128 v[116:119], v6 offset:0
    ds_read_b128 v[144:147], v6 offset:7168
    ds_read_b128 v[172:175], v6 offset:14336
    ds_read_b128 v[200:203], v6 offset:21504
    ds_read_b128 v[92:95], v19 offset:64
    ds_read_b128 v[120:123], v6 offset:1024
    ds_read_b128 v[148:151], v6 offset:8192
    ds_read_b128 v[176:179], v6 offset:15360
    ds_read_b128 v[204:207], v6 offset:22528
    ds_read_b128 v[96:99], v19 offset:128
    ds_read_b128 v[124:127], v6 offset:2048
    ds_read_b128 v[152:155], v6 offset:9216
    ds_read_b128 v[180:183], v6 offset:16384
    ds_read_b128 v[208:211], v6 offset:23552
    s_waitcnt lgkmcnt(14)
    v_mfma_f32_16x16x32_bf16 v[84:87], v[88:91], v[88:91], 0
    s_waitcnt lgkmcnt(13)
    v_mfma_f32_16x16x32_bf16 v[52:55], v[116:119], v[88:91], 0
    s_waitcnt lgkmcnt(12)
    v_mfma_f32_16x16x32_bf16 v[56:59], v[144:147], v[88:91], 0
    s_waitcnt lgkmcnt(11)
    v_mfma_f32_16x16x32_bf16 v[60:63], v[172:175], v[88:91], 0
    s_waitcnt lgkmcnt(10)
    v_mfma_f32_16x16x32_bf16 v[64:67], v[200:203], v[88:91], 0
    ds_read_b128 v[100:103], v19 offset:192
    ds_read_b128 v[128:131], v6 offset:3072
    ds_read_b128 v[156:159], v6 offset:10240
    ds_read_b128 v[184:187], v6 offset:17408
    ds_read_b128 v[212:215], v6 offset:24576
    s_waitcnt lgkmcnt(14)
    v_mfma_f32_16x16x32_bf16 v[84:87], v[92:95], v[92:95], v[84:87]
    s_waitcnt lgkmcnt(13)
    v_mfma_f32_16x16x32_bf16 v[52:55], v[120:123], v[92:95], v[52:55]
    s_waitcnt lgkmcnt(12)
    v_mfma_f32_16x16x32_bf16 v[56:59], v[148:151], v[92:95], v[56:59]
    s_waitcnt lgkmcnt(11)
    v_mfma_f32_16x16x32_bf16 v[60:63], v[176:179], v[92:95], v[60:63]
    s_waitcnt lgkmcnt(10)
    v_mfma_f32_16x16x32_bf16 v[64:67], v[204:207], v[92:95], v[64:67]
    ds_read_b128 v[104:107], v19 offset:256
    ds_read_b128 v[132:135], v6 offset:4096
    ds_read_b128 v[160:163], v6 offset:11264
    ds_read_b128 v[188:191], v6 offset:18432
    ds_read_b128 v[216:219], v6 offset:25600
    s_waitcnt lgkmcnt(14)
    v_mfma_f32_16x16x32_bf16 v[84:87], v[96:99], v[96:99], v[84:87]
    s_waitcnt lgkmcnt(13)
    v_mfma_f32_16x16x32_bf16 v[52:55], v[124:127], v[96:99], v[52:55]
    s_waitcnt lgkmcnt(12)
    v_mfma_f32_16x16x32_bf16 v[56:59], v[152:155], v[96:99], v[56:59]
    s_waitcnt lgkmcnt(11)
    v_mfma_f32_16x16x32_bf16 v[60:63], v[180:183], v[96:99], v[60:63]
    s_waitcnt lgkmcnt(10)
    v_mfma_f32_16x16x32_bf16 v[64:67], v[208:211], v[96:99], v[64:67]
    ds_read_b128 v[108:111], v19 offset:320
    ds_read_b128 v[136:139], v6 offset:5120
    ds_read_b128 v[164:167], v6 offset:12288
    ds_read_b128 v[192:195], v6 offset:19456
    ds_read_b128 v[220:223], v6 offset:26624
    s_waitcnt lgkmcnt(14)
    v_mfma_f32_16x16x32_bf16 v[84:87], v[100:103], v[100:103], v[84:87]
    s_waitcnt lgkmcnt(13)
    v_mfma_f32_16x16x32_bf16 v[52:55], v[128:131], v[100:103], v[52:55]
    s_waitcnt lgkmcnt(12)
    v_mfma_f32_16x16x32_bf16 v[56:59], v[156:159], v[100:103], v[56:59]
    s_waitcnt lgkmcnt(11)
    v_mfma_f32_16x16x32_bf16 v[60:63], v[184:187], v[100:103], v[60:63]
    s_waitcnt lgkmcnt(10)
    v_mfma_f32_16x16x32_bf16 v[64:67], v[212:215], v[100:103], v[64:67]
    ds_read_b128 v[112:115], v19 offset:384
    ds_read_b128 v[140:143], v6 offset:6144
    ds_read_b128 v[168:171], v6 offset:13312
    ds_read_b128 v[196:199], v6 offset:20480
    ds_read_b128 v[224:227], v6 offset:27648
    s_waitcnt lgkmcnt(14)
    v_mfma_f32_16x16x32_bf16 v[84:87], v[104:107], v[104:107], v[84:87]
    s_waitcnt lgkmcnt(13)
    v_mfma_f32_16x16x32_bf16 v[52:55], v[132:135], v[104:107], v[52:55]
    s_waitcnt lgkmcnt(12)
    v_mfma_f32_16x16x32_bf16 v[56:59], v[160:163], v[104:107], v[56:59]
    s_waitcnt lgkmcnt(11)
    v_mfma_f32_16x16x32_bf16 v[60:63], v[188:191], v[104:107], v[60:63]
    s_waitcnt lgkmcnt(10)
    v_mfma_f32_16x16x32_bf16 v[64:67], v[216:219], v[104:107], v[64:67]
    s_waitcnt lgkmcnt(9)
    v_mfma_f32_16x16x32_bf16 v[84:87], v[108:111], v[108:111], v[84:87]
    s_waitcnt lgkmcnt(8)
    v_mfma_f32_16x16x32_bf16 v[52:55], v[136:139], v[108:111], v[52:55]
    s_waitcnt lgkmcnt(7)
    v_mfma_f32_16x16x32_bf16 v[56:59], v[164:167], v[108:111], v[56:59]
    s_waitcnt lgkmcnt(6)
    v_mfma_f32_16x16x32_bf16 v[60:63], v[192:195], v[108:111], v[60:63]
    s_waitcnt lgkmcnt(5)
    v_mfma_f32_16x16x32_bf16 v[64:67], v[220:223], v[108:111], v[64:67]
    s_barrier
    ds_read_b128 v[88:91], v19 offset:30720
    ds_read_b128 v[92:95], v19 offset:30784
    ds_read_b128 v[96:99], v19 offset:30848
    ds_read_b128 v[100:103], v19 offset:30912
    ds_read_b128 v[104:107], v19 offset:30976
    ds_read_b128 v[108:111], v19 offset:31040
    s_waitcnt lgkmcnt(10)
    v_mfma_f32_16x16x32_bf16 v[84:87], v[112:115], v[112:115], v[84:87]
    s_waitcnt lgkmcnt(9)
    v_mfma_f32_16x16x32_bf16 v[52:55], v[140:143], v[112:115], v[52:55]
    s_waitcnt lgkmcnt(8)
    v_mfma_f32_16x16x32_bf16 v[56:59], v[168:171], v[112:115], v[56:59]
    s_waitcnt lgkmcnt(7)
    v_mfma_f32_16x16x32_bf16 v[60:63], v[196:199], v[112:115], v[60:63]
    s_waitcnt lgkmcnt(6)
    v_mfma_f32_16x16x32_bf16 v[64:67], v[224:227], v[112:115], v[64:67]
    ds_read_b128 v[112:115], v19 offset:31104
    s_waitcnt lgkmcnt(6)
    v_mfma_f32_16x16x32_bf16 v[84:87], v[88:91], v[88:91], v[84:87]
    v_mfma_f32_16x16x32_bf16 v[72:75], v[144:147], v[88:91], 0
    s_waitcnt lgkmcnt(5)
    v_mfma_f32_16x16x32_bf16 v[84:87], v[92:95], v[92:95], v[84:87]
    v_mfma_f32_16x16x32_bf16 v[72:75], v[148:151], v[92:95], v[72:75]
    s_waitcnt lgkmcnt(4)
    v_mfma_f32_16x16x32_bf16 v[84:87], v[96:99], v[96:99], v[84:87]
    v_mfma_f32_16x16x32_bf16 v[72:75], v[152:155], v[96:99], v[72:75]
    s_waitcnt lgkmcnt(3)
    v_mfma_f32_16x16x32_bf16 v[84:87], v[100:103], v[100:103], v[84:87]
    v_mfma_f32_16x16x32_bf16 v[72:75], v[156:159], v[100:103], v[72:75]
    s_waitcnt lgkmcnt(2)
    v_mfma_f32_16x16x32_bf16 v[84:87], v[104:107], v[104:107], v[84:87]
    v_mfma_f32_16x16x32_bf16 v[72:75], v[160:163], v[104:107], v[72:75]
    s_waitcnt lgkmcnt(1)
    v_mfma_f32_16x16x32_bf16 v[84:87], v[108:111], v[108:111], v[84:87]
    v_mfma_f32_16x16x32_bf16 v[72:75], v[164:167], v[108:111], v[72:75]
    s_waitcnt lgkmcnt(0)
    v_mfma_f32_16x16x32_bf16 v[84:87], v[112:115], v[112:115], v[84:87]
    v_mfma_f32_16x16x32_bf16 v[72:75], v[168:171], v[112:115], v[72:75]
    ds_read_b128 v[144:147], v20 offset:0
    ds_read_b128 v[148:151], v20 offset:64
    ds_read_b128 v[152:155], v20 offset:128
    ds_read_b128 v[156:159], v20 offset:192
    v_mfma_f32_16x16x32_bf16 v[68:71], v[116:119], v[88:91], 0
    v_mfma_f32_16x16x32_bf16 v[76:79], v[172:175], v[88:91], 0
    v_mov_b32 v22, 0
    v_mov_b32 v16, 90368
    v_mfma_f32_16x16x32_bf16 v[80:83], v[200:203], v[88:91], 0
    v_cndmask_b32 v22, v22, v84, s[30:31]
    v_cndmask_b32 v22, v22, v85, s[32:33]
    v_mfma_f32_16x16x32_bf16 v[68:71], v[120:123], v[92:95], v[68:71]
    v_cndmask_b32 v22, v22, v86, s[34:35]
    v_cndmask_b32 v22, v22, v87, s[36:37]
    v_mfma_f32_16x16x32_bf16 v[76:79], v[176:179], v[92:95], v[76:79]
    v_add_f32 v23, v59, v75
    v_cndmask_b32 v23, 0, v23, s[24:25]
    v_mfma_f32_16x16x32_bf16 v[80:83], v[204:207], v[92:95], v[80:83]
    v_mfma_f32_16x16x32_bf16 v[68:71], v[124:127], v[96:99], v[68:71]
    v_permlane32_swap_b32 v22, v23
    v_add_f32 v22, v22, v23
    v_mfma_f32_16x16x32_bf16 v[76:79], v[180:183], v[96:99], v[76:79]
    v_mov_b32 v23, v22
    v_mfma_f32_16x16x32_bf16 v[80:83], v[208:211], v[96:99], v[80:83]
    s_nop 0
    v_permlane16_swap_b32 v22, v23
    v_mfma_f32_16x16x32_bf16 v[68:71], v[128:131], v[100:103], v[68:71]
    v_add_f32 v22, v22, v23
    v_mov_b32 v23, v22
    v_mfma_f32_16x16x32_bf16 v[76:79], v[184:187], v[100:103], v[76:79]
    v_mfma_f32_16x16x32_bf16 v[80:83], v[212:215], v[100:103], v[80:83]
    v_permlane32_swap_b32 v22, v23
    v_mul_f32 v24, 0xbb124925, v23
    v_mfma_f32_16x16x32_bf16 v[68:71], v[132:135], v[104:107], v[68:71]
    v_mul_f32 v22, 0x3b124925, v22
    v_fma_f32 v22, -v24, v24, v22
    v_mfma_f32_16x16x32_bf16 v[76:79], v[188:191], v[104:107], v[76:79]
    v_max_f32 v22, 0, v22
    v_cvt_pk_bf16_f32 v235, v24, v24
    v_mfma_f32_16x16x32_bf16 v[80:83], v[216:219], v[104:107], v[80:83]
    v_and_b32 v235, 0xffff0000, v235
    v_sub_f32 v235, v235, v24
    v_mfma_f32_16x16x32_bf16 v[68:71], v[136:139], v[108:111], v[68:71]
    v_mul_f32 v235, 0x43e00000, v235
    v_cvt_pk_bf16_f32 v22, v22, v22
    v_mfma_f32_16x16x32_bf16 v[76:79], v[192:195], v[108:111], v[76:79]
    v_and_b32 v22, 0xffff0000, v22
    v_add_f32 v22, 0x3727c5ac, v22
    v_mfma_f32_16x16x32_bf16 v[80:83], v[220:223], v[108:111], v[80:83]
    v_cvt_pk_bf16_f32 v22, v22, v22
    v_and_b32 v22, 0xffff0000, v22
    v_mfma_f32_16x16x32_bf16 v[68:71], v[140:143], v[112:115], v[68:71]
    v_sqrt_f32 v22, v22
    v_mfma_f32_16x16x32_bf16 v[76:79], v[196:199], v[112:115], v[76:79]
    v_cvt_pk_bf16_f32 v22, v22, v22
    v_and_b32 v22, 0xffff0000, v22
    v_mfma_f32_16x16x32_bf16 v[80:83], v[224:227], v[112:115], v[80:83]
    v_rcp_f32 v26, v22
    s_waitcnt lgkmcnt(0)
    v_pk_fma_f32 v[56:57], v[72:73], v[232:233], v[56:57]
    v_pk_fma_f32 v[58:59], v[74:75], v[232:233], v[58:59]
    v_mul_f32 v24, v24, v26
    v_mul_f32 v235, v235, v26
    v_mul_f32 v144, v144, v24
    v_mul_f32 v145, v145, v24
    v_mul_f32 v146, v146, v24
    v_mul_f32 v147, v147, v24
    v_mul_f32 v148, v148, v24
    v_mul_f32 v149, v149, v24
    v_mul_f32 v150, v150, v24
    v_mul_f32 v151, v151, v24
    v_mul_f32 v152, v152, v24
    v_mul_f32 v153, v153, v24
    v_mul_f32 v154, v154, v24
    v_mul_f32 v155, v155, v24
    v_mul_f32 v156, v156, v24
    v_mul_f32 v157, v157, v24
    v_mul_f32 v158, v158, v24
    v_mul_f32 v159, v159, v24
    v_pk_fma_f32 v[52:53], v[68:69], v[232:233], v[52:53]
    v_pk_fma_f32 v[54:55], v[70:71], v[232:233], v[54:55]
    v_pk_fma_f32 v[60:61], v[76:77], v[232:233], v[60:61]
    v_pk_fma_f32 v[62:63], v[78:79], v[232:233], v[62:63]
    v_pk_fma_f32 v[64:65], v[80:81], v[232:233], v[64:65]
    v_pk_fma_f32 v[66:67], v[82:83], v[232:233], v[66:67]
    v_pk_fma_f32 v[56:57], v[56:57], v[26:27], v[148:149] op_sel_hi:[1,0,1]
    v_pk_fma_f32 v[58:59], v[58:59], v[26:27], v[150:151] op_sel_hi:[1,0,1]
    v_pk_fma_f32 v[52:53], v[52:53], v[26:27], v[144:145] op_sel_hi:[1,0,1]
    v_pk_fma_f32 v[54:55], v[54:55], v[26:27], v[146:147] op_sel_hi:[1,0,1]
    v_pk_fma_f32 v[60:61], v[60:61], v[26:27], v[152:153] op_sel_hi:[1,0,1]
    v_pk_fma_f32 v[62:63], v[62:63], v[26:27], v[154:155] op_sel_hi:[1,0,1]
    v_pk_fma_f32 v[64:65], v[64:65], v[26:27], v[156:157] op_sel_hi:[1,0,1]
    v_pk_fma_f32 v[66:67], v[66:67], v[26:27], v[158:159] op_sel_hi:[1,0,1]
    v_cndmask_b32 v66, v66, v235, s[38:39]
    v_cvt_pk_f16_f32 v70, v56, v57
    v_cvt_pk_f16_f32 v71, v58, v59
    ds_write_b64 v17, v[70:71] offset:32
    v_cvt_pk_f16_f32 v68, v52, v53
    v_cvt_pk_f16_f32 v69, v54, v55
    ds_write_b64 v17, v[68:69] offset:0
    v_cvt_pk_f16_f32 v72, v60, v61
    v_cvt_pk_f16_f32 v73, v62, v63
    ds_write_b64 v17, v[72:73] offset:64
    v_cvt_pk_f16_f32 v74, v64, v65
    v_cvt_pk_f16_f32 v75, v66, v67
    ds_write_b64 v17, v[74:75] offset:96
    s_waitcnt lgkmcnt(0)
    s_barrier
    ds_read_b64_tr_b16 v[164:165], v18 offset:0
    ds_read_b64_tr_b16 v[166:167], v18 offset:544
    ds_read_b64_tr_b16 v[180:181], v18 offset:64
    ds_read_b64_tr_b16 v[182:183], v18 offset:608
    ds_read_b64_tr_b16 v[168:169], v18 offset:4352
    ds_read_b64_tr_b16 v[170:171], v18 offset:4896
    ds_read_b64_tr_b16 v[184:185], v18 offset:4416
    ds_read_b64_tr_b16 v[186:187], v18 offset:4960
    ds_read_b64_tr_b16 v[172:173], v18 offset:32
    ds_read_b64_tr_b16 v[174:175], v18 offset:576
    ds_read_b64_tr_b16 v[188:189], v18 offset:96
    ds_read_b64_tr_b16 v[190:191], v18 offset:640
    ds_read_b64_tr_b16 v[176:177], v18 offset:4384
    ds_read_b64_tr_b16 v[178:179], v18 offset:4928
    ds_read_b64_tr_b16 v[192:193], v18 offset:4448
    ds_read_b64_tr_b16 v[194:195], v18 offset:4992
    ds_read_b32 v16, v16
    s_waitcnt lgkmcnt(15)
    v_mfma_f32_16x16x32_f16 v[52:55], v[164:167], v[28:31], 0
    v_mfma_f32_16x16x32_f16 v[60:63], v[164:167], v[44:47], 0
    s_waitcnt lgkmcnt(13)
    v_mfma_f32_16x16x32_f16 v[52:55], v[180:183], v[36:39], v[52:55]
    v_mfma_f32_16x16x32_f16 v[60:63], v[180:183], v[28:31], v[60:63]
    s_waitcnt lgkmcnt(11)
    v_mfma_f32_16x16x32_f16 v[52:55], v[168:171], v[32:35], v[52:55]
    v_mfma_f32_16x16x32_f16 v[60:63], v[168:171], v[48:51], v[60:63]
    s_waitcnt lgkmcnt(9)
    v_mfma_f32_16x16x32_f16 v[52:55], v[184:187], v[40:43], v[52:55]
    v_mfma_f32_16x16x32_f16 v[60:63], v[184:187], v[32:35], v[60:63]
    s_waitcnt lgkmcnt(7)
    v_mfma_f32_16x16x32_f16 v[56:59], v[172:175], v[28:31], 0
    v_mfma_f32_16x16x32_f16 v[64:67], v[172:175], v[44:47], 0
    s_waitcnt lgkmcnt(5)
    v_mfma_f32_16x16x32_f16 v[56:59], v[188:191], v[36:39], v[56:59]
    v_mfma_f32_16x16x32_f16 v[64:67], v[188:191], v[28:31], v[64:67]
    s_waitcnt lgkmcnt(3)
    v_mfma_f32_16x16x32_f16 v[56:59], v[176:179], v[32:35], v[56:59]
    v_mfma_f32_16x16x32_f16 v[64:67], v[176:179], v[48:51], v[64:67]
    s_waitcnt lgkmcnt(1)
    v_mfma_f32_16x16x32_f16 v[56:59], v[192:195], v[40:43], v[56:59]
    v_mfma_f32_16x16x32_f16 v[64:67], v[192:195], v[32:35], v[64:67]
    s_waitcnt lgkmcnt(0)
    v_add_u32 v24, 1, v16
    s_mov_b32 s98, 0x9e3779b1
    v_mul_lo_u32 v24, v24, s98
    v_cvt_pk_f16_f32 v88, v52, v60
    v_cvt_pk_f16_f32 v89, v53, v61
    v_cvt_pk_f16_f32 v90, v54, v62
    v_cvt_pk_f16_f32 v91, v55, v63
    buffer_store_dwordx4 v[88:91], v21, s[12:15], s23 offen sc1
    v_add3_u32 v22, v88, v89, v90
    v_sub_u32 v24, v24, v91
    v_sub_u32 v24, v24, v22
    v_cvt_pk_f16_f32 v92, v56, v64
    v_cvt_pk_f16_f32 v93, v57, v65
    v_cvt_pk_f16_f32 v94, v58, v66
    v_add3_u32 v22, v92, v93, v94
    v_sub_u32 v95, v24, v22
    buffer_store_dwordx4 v[92:95], v21, s[12:15], s23 offen offset:128 sc1
    s_setprio 0
    buffer_load_dwordx4 v[12:15], v7, s[16:19], 0 offen
    buffer_load_dwordx4 v[8:11], v7, s[8:11], s97 offen
Lpro1:
    s_lshl_b32 s28, s92, 16
    s_lshl_b32 s29, s20, 8
    s_add_u32 s28, s28, s29
    s_add_u32 s29, s28, 4096
    s_add_u32 s30, s28, 32768
    s_add_u32 s31, s28, 36864
    v_lshlrev_b32 v41, 13, v3
    v_lshl_add_u32 v41, v2, 4, v41
    v_and_b32 v4, 7, v2
    v_lshlrev_b32 v4, 6, v4
    v_add_u32 v4, s95, v4
    v_cvt_f32_u32 v4, v4
    v_cmp_gt_u32 vcc, 8, v2
    v_mul_f32 v112, 0x3a000000, v4
    v_lshlrev_b32 v5, 2, v3
    v_cndmask_b32 v112, -v112, v112, vcc
    v_cvt_f32_u32 v5, v5
    v_mul_f32 v113, v5, v112
    v_mov_b32 v104, v113
    v_fmamk_f32 v105, v112, 0x3f800000, v113
    v_fmamk_f32 v106, v112, 0x40000000, v113
    v_fmamk_f32 v107, v112, 0x40400000, v113
    v_sin_f32 v108, v104
    v_cos_f32 v104, v104
    v_sin_f32 v109, v105
    v_cos_f32 v105, v105
    v_sin_f32 v110, v106
    v_cos_f32 v106, v106
    v_sin_f32 v111, v107
    v_cos_f32 v107, v107
    v_cvt_pk_f16_f32 v28, v104, v108
    v_cvt_pk_f16_f32 v29, v105, v109
    v_cvt_pk_f16_f32 v30, v106, v110
    v_cvt_pk_f16_f32 v31, v107, v111
    v_fmamk_f32 v104, v112, 0x41800000, v113
    v_fmamk_f32 v105, v112, 0x41880000, v113
    v_fmamk_f32 v106, v112, 0x41900000, v113
    v_fmamk_f32 v107, v112, 0x41980000, v113
    v_sin_f32 v108, v104
    v_cos_f32 v104, v104
    v_sin_f32 v109, v105
    v_cos_f32 v105, v105
    v_sin_f32 v110, v106
    v_cos_f32 v106, v106
    v_sin_f32 v111, v107
    v_cos_f32 v107, v107
    v_cvt_pk_f16_f32 v32, v104, v108
    v_cvt_pk_f16_f32 v33, v105, v109
    v_cvt_pk_f16_f32 v34, v106, v110
    v_cvt_pk_f16_f32 v35, v107, v111
    v_lshrrev_b32 v4, 3, v2
    v_and_b32 v5, 3, v2
    v_mul_u32_u24 v5, 7, v5
    v_lshl_add_u32 v5, v4, 2, v5
    s_mul_i32 s32, s20, 28
    s_add_u32 s32, s32, 1
    v_add_u32 v5, s32, v5
    v_sub_u32 v6, 448, v5
    v_cmp_gt_u32 s[34:35], 2, v3
    v_mov_b32 v104, s93
    v_mov_b32 v105, s94
    v_cndmask_b32 v6, v6, v5, s[34:35]
    v_cndmask_b32 v104, v105, v104, s[34:35]
    v_bfe_u32 v105, v2, 2, 1
    v_cmp_eq_u32 s[60:61], v104, v105
    v_and_b32 v106, 1, v3
    v_mul_u32_u24 v106, 2048, v106
    v_add_lshl_u32 v36, v106, v6, 2
    v_mov_b32 v107, -4
    v_cndmask_b32 v107, v107, 4, s[34:35]
    v_add_u32 v37, v36, v107
    v_add_u32 v38, v37, v107
    v_add_u32 v39, v38, v107
    v_cmp_eq_u32 s[50:51], 0, v4
    s_and_b64 s[50:51], s[50:51], s[60:61]
    v_mov_b32 v104, 222
    v_cmp_eq_u32 s[62:63], v104, v5
    s_and_b64 s[62:63], s[62:63], s[60:61]
    s_andn2_b64 s[36:37], s[62:63], s[34:35]
    v_lshlrev_b32 v106, 2, v106
    v_add_u32 v104, 1792, v106
    v_cndmask_b32 v38, v38, v104, s[36:37]
    v_add_u32 v104, 1796, v106
    v_add_u32 v244, 1800, v106
    v_cndmask_b32 v244, v244, v104, s[34:35]
    s_mul_i32 s33, s20, 2048
    v_lshlrev_b32 v40, 5, v1
    v_add_u32 v40, s33, v40
    s_add_u32 s33, s33, 1792
    v_mov_b32 v245, s33
    v_alignbit_b32 v236, v28, v28, 16
    v_xor_b32 v236, 0x8000, v236
    v_alignbit_b32 v237, v29, v29, 16
    v_xor_b32 v237, 0x8000, v237
    v_alignbit_b32 v238, v30, v30, 16
    v_xor_b32 v238, 0x8000, v238
    v_alignbit_b32 v239, v31, v31, 16
    v_xor_b32 v239, 0x8000, v239
    v_alignbit_b32 v240, v32, v32, 16
    v_xor_b32 v240, 0x8000, v240
    v_alignbit_b32 v241, v33, v33, 16
    v_xor_b32 v241, 0x8000, v241
    v_alignbit_b32 v242, v34, v34, 16
    v_xor_b32 v242, 0x8000, v242
    v_alignbit_b32 v243, v35, v35, 16
    v_xor_b32 v243, 0x8000, v243
    v_and_b32 v4, 1, v1
    v_cmp_eq_u32 vcc, 0, v4
    s_nop 1
    v_cndmask_b32 v42, 0, -1, vcc
    v_and_b32 v4, 2, v1
    v_cmp_eq_u32 vcc, 0, v4
    s_nop 1
    v_cndmask_b32 v43, 0, -1, vcc
    v_and_b32 v4, 4, v1
    v_cmp_eq_u32 vcc, 0, v4
    s_nop 1
    v_cndmask_b32 v44, 0, -1, vcc
    s_lshl_b32 s34, s20, 5
    s_add_u32 s34, s34, 16384
    v_lshlrev_b32 v5, 2, v1
    v_add_u32 v45, s34, v5
    v_add_u32 v46, 16384, v5
    v_lshrrev_b32 v47, 1, v0
    v_lshlrev_b32 v47, 5, v47
    v_and_b32 v4, 1, v0
    v_lshl_add_u32 v47, v4, 4, v47
    s_lshl_b32 s34, s20, 6
    s_add_u32 s34, s34, 16640
    v_add_u32 v48, s34, v5
    v_lshrrev_b32 v51, 3, v1
    v_and_b32 v50, 7, v1
    v_lshlrev_b32 v49, 6, v51
    v_lshl_add_u32 v49, v50, 2, v49
    v_add_u32 v49, 16640, v49
    v_lshlrev_b32 v50, 6, v50
    v_add_u32 v50, 16672, v50
    v_lshlrev_b32 v51, 7, v51
    s_cmp_ge_u32 s2, 224
    s_cselect_b32 s33, 1024, 0
    s_add_u32 s33, s33, 4194304
    s_mov_b32 s27, s2
    s_lshl_b32 s27, s27, 5
    s_add_u32 s27, s27, 2228224
    s_sub_u32 s32, 2047, s96
    v_lshrrev_b32 v4, 1, v0
    v_and_b32 v5, 7, v4
    v_lshrrev_b32 v6, 6, v4
    v_lshl_or_b32 v5, v6, 3, v5
    v_sub_u32 v6, 64, v5
    v_cmp_eq_u32 vcc, 0, v5
    v_bfe_u32 v104, v4, 3, 1
    s_nop 0
    v_cndmask_b32 v6, v6, 32, vcc
    v_cmp_eq_u32 vcc, 0, v104
    v_bfe_u32 v104, v4, 4, 2
    s_nop 0
    v_cndmask_b32 v5, v6, v5, vcc
    v_lshl_add_u32 v5, v104, 9, v5
    v_and_b32 v4, 1, v0
    v_lshl_add_u32 v5, v4, 8, v5
    v_sub_u32 v224, 2047, v5
    v_subrev_u32 v225, 64, v224
    v_subrev_u32 v226, 128, v224
    v_subrev_u32 v227, 192, v224
    s_mov_b32 s16, s42
    s_and_b32 s17, s43, 0xffff
    s_mov_b32 s18, 1605632
    s_mov_b32 s19, 0x00020000
    v_mul_u32_u24 v234, 3584, v0
    s_and_b32 s100, s2, 7
    s_mul_i32 s100, s100, 28
    s_lshr_b32 s101, s2, 3
    s_add_u32 s100, s100, s101
    s_lshl_b32 s26, s100, 4
    s_lshl_b32 s101, s20, 10
    s_add_u32 s101, s101, 99088
    s_and_b32 s45, s45, 0xffff
    s_cmp_ge_u32 s2, 224
    s_cselect_b32 s24, 7, s20
Lpro2:
    v_readfirstlane_b32 s56, v16
    s_add_u32 s56, s56, 1
    s_mul_i32 s98, s56, 0x9e3779b1
    s_lshl_b32 s99, s98, 6
    s_and_b32 s59, s56, 0xffff
    s_barrier
    s_sleep 4
    s_mov_b32 s57, 4000000
    buffer_load_dwordx4 v[116:119], v41, s[12:15], s28 offen offset:0 sc1
    buffer_load_dwordx4 v[120:123], v41, s[12:15], s28 offen offset:2048 sc1
    buffer_load_dwordx4 v[124:127], v41, s[12:15], s29 offen offset:0 sc1
    buffer_load_dwordx4 v[128:131], v41, s[12:15], s29 offen offset:2048 sc1
    buffer_load_dwordx4 v[132:135], v41, s[12:15], s30 offen offset:0 sc1
    buffer_load_dwordx4 v[136:139], v41, s[12:15], s30 offen offset:2048 sc1
    buffer_load_dwordx4 v[140:143], v41, s[12:15], s31 offen offset:0 sc1
    buffer_load_dwordx4 v[144:147], v41, s[12:15], s31 offen offset:2048 sc1
    s_waitcnt vmcnt(8)
    v_lshlrev_b32 v76, 16, v12
    v_and_b32 v77, 0xffff0000, v12
    v_lshlrev_b32 v78, 16, v13
    v_and_b32 v79, 0xffff0000, v13
    v_lshlrev_b32 v80, 16, v14
    v_and_b32 v81, 0xffff0000, v14
    v_lshlrev_b32 v82, 16, v15
    v_and_b32 v83, 0xffff0000, v15
    v_pk_add_f32 v[104:105], v[76:77], v[78:79]
    v_pk_add_f32 v[106:107], v[80:81], v[82:83]
    v_pk_add_f32 v[104:105], v[104:105], v[106:107]
    v_add_f32 v104, v104, v105
    v_mov_b32 v106, 0
    v_mov_b32 v108, 0
    v_mov_b32 v4, v108
    v_permlane32_swap_b32 v104, v106
    s_nop 0
    v_permlane32_swap_b32 v108, v4
    v_add_f32 v104, v104, v106
    v_add_f32 v108, v108, v4
    s_nop 1
    v_permlane16_swap_b32 v104, v108
    v_add_f32 v104, v104, v108
    s_nop 1
    v_add_f32_dpp v104, v104, v104 row_ror:8 row_mask:0xf bank_mask:0xf
    s_nop 1
    v_add_f32_dpp v104, v104, v104 row_ror:4 row_mask:0xf bank_mask:0xf
    s_nop 1
    v_add_f32_dpp v104, v104, v104 row_ror:2 row_mask:0xf bank_mask:0xf
    s_nop 1
    v_add_f32_dpp v104, v104, v104 row_ror:1 row_mask:0xf bank_mask:0xf
    s_nop 0
    v_readlane_b32 s58, v104, 0
    v_readlane_b32 s39, v104, 16
    v_readlane_b32 s39, v104, 32
    v_lshlrev_b32 v68, 16, v8
    v_and_b32 v69, 0xffff0000, v8
    v_lshlrev_b32 v70, 16, v9
    v_and_b32 v71, 0xffff0000, v9
    v_lshlrev_b32 v72, 16, v10
    v_and_b32 v73, 0xffff0000, v10
    v_lshlrev_b32 v74, 16, v11
    v_and_b32 v75, 0xffff0000, v11
    v_mov_b32 v88, 0
    v_mov_b32 v89, 0
    v_mov_b32 v90, 0
    v_mov_b32 v91, 0
    v_mov_b32 v92, 0
    v_mov_b32 v93, 0
    s_branch Lupw
Lupoll:
    buffer_load_dwordx4 v[116:119], v41, s[12:15], s28 offen offset:0 sc1
    buffer_load_dwordx4 v[120:123], v41, s[12:15], s28 offen offset:2048 sc1
    buffer_load_dwordx4 v[124:127], v41, s[12:15], s29 offen offset:0 sc1
    buffer_load_dwordx4 v[128:131], v41, s[12:15], s29 offen offset:2048 sc1
    buffer_load_dwordx4 v[132:135], v41, s[12:15], s30 offen offset:0 sc1
    buffer_load_dwordx4 v[136:139], v41, s[12:15], s30 offen offset:2048 sc1
    buffer_load_dwordx4 v[140:143], v41, s[12:15], s31 offen offset:0 sc1
    buffer_load_dwordx4 v[144:147], v41, s[12:15], s31 offen offset:2048 sc1
Lupw:
    s_waitcnt vmcnt(4)
    v_add_u32 v4, v116, v117
    v_add3_u32 v4, v4, v118, v119
    v_add3_u32 v4, v4, v120, v121
    v_add3_u32 v4, v4, v122, v123
    v_add3_u32 v4, v4, v124, v125
    v_add3_u32 v4, v4, v126, v127
    v_add3_u32 v4, v4, v128, v129
    v_add3_u32 v4, v4, v130, v131
    v_swap_b32 v117, v120
    v_swap_b32 v118, v124
    v_swap_b32 v119, v128
    v_swap_b32 v122, v125
    v_swap_b32 v123, v129
    v_swap_b32 v127, v130
    v_mfma_f32_16x16x32_f16 v[52:55], v[28:31], v[116:119], 0
    v_mfma_f32_16x16x32_f16 v[56:59], v[28:31], v[120:123], 0
    v_mfma_f32_16x16x32_f16 v[60:63], v[28:31], v[124:127], 0
    v_mfma_f32_16x16x32_f16 v[64:67], v[28:31], v[128:131], 0
    v_mfma_f32_16x16x32_f16 v[96:99], v[236:239], v[124:127], 0
    s_waitcnt vmcnt(0)
    v_add3_u32 v4, v4, v132, v133
    v_add3_u32 v4, v4, v134, v135
    v_add3_u32 v4, v4, v136, v137
    v_add3_u32 v4, v4, v138, v139
    v_add3_u32 v4, v4, v140, v141
    v_add3_u32 v4, v4, v142, v143
    v_add3_u32 v4, v4, v144, v145
    v_add3_u32 v4, v4, v146, v147
    v_swap_b32 v133, v136
    v_swap_b32 v134, v140
    v_swap_b32 v135, v144
    v_swap_b32 v138, v141
    v_swap_b32 v139, v145
    v_swap_b32 v143, v146
    v_mfma_f32_16x16x32_f16 v[52:55], v[32:35], v[132:135], v[52:55]
    v_add_u32_dpp v4, v4, v4 row_ror:8 row_mask:0xf bank_mask:0xf
    v_mfma_f32_16x16x32_f16 v[56:59], v[32:35], v[136:139], v[56:59]
    s_nop 0
    v_add_u32_dpp v4, v4, v4 row_ror:4 row_mask:0xf bank_mask:0xf
    v_mfma_f32_16x16x32_f16 v[60:63], v[32:35], v[140:143], v[60:63]
    s_nop 0
    v_add_u32_dpp v4, v4, v4 row_ror:2 row_mask:0xf bank_mask:0xf
    v_mfma_f32_16x16x32_f16 v[64:67], v[32:35], v[144:147], v[64:67]
    s_nop 0
    v_add_u32_dpp v4, v4, v4 row_ror:1 row_mask:0xf bank_mask:0xf
    v_mfma_f32_16x16x32_f16 v[96:99], v[240:243], v[140:143], v[96:99]
    v_cmp_ne_u32 vcc, s99, v4
    s_cmp_eq_u64 vcc, 0
    s_cbranch_scc1 Lupolld
    s_sub_u32 s57, s57, 1
    s_cbranch_scc0 Lupoll
Lupolld:
    s_mov_b64 exec, s[60:61]
    ds_write2st64_b32 v36, v52, v53 offset0:0 offset1:8
    ds_write2st64_b32 v36, v54, v55 offset0:16 offset1:24
    ds_write2st64_b32 v37, v56, v57 offset0:0 offset1:8
    ds_write2st64_b32 v37, v58, v59 offset0:16 offset1:24
    ds_write2st64_b32 v38, v60, v61 offset0:0 offset1:8
    ds_write2st64_b32 v38, v62, v63 offset0:16 offset1:24
    s_mov_b64 exec, s[50:51]
    ds_write2st64_b32 v39, v64, v65 offset0:0 offset1:8
    ds_write2st64_b32 v39, v66, v67 offset0:16 offset1:24
    s_cmp_lg_u32 s20, 7
    s_cbranch_scc1 Lndc
    s_mov_b64 exec, s[62:63]
    ds_write2st64_b32 v244, v96, v97 offset0:0 offset1:8
    ds_write2st64_b32 v244, v98, v99 offset0:16 offset1:24
Lndc:
    s_mov_b64 exec, -1
    s_cmp_eq_u32 s24, 7
    s_cbranch_scc1 Lngu
    s_mov_b32 m0, s101
    s_add_u32 s101, s101, 8192
    buffer_load_dwordx4 v234, s[16:19], s26 offen lds
    s_mov_b32 s16, s44
    s_mov_b32 m0, s101
    s_mov_b32 s17, s45
    buffer_load_dwordx4 v234, s[16:19], s26 offen lds
Lngu:
    s_mov_b32 exec_hi, 0x00ffffff
    s_waitcnt lgkmcnt(0)
    s_barrier
    ds_read_b128 v[96:99], v245
    ds_read_b128 v[116:119], v40 offset:0
    ds_read_b128 v[120:123], v40 offset:16
    s_mov_b64 s[36:37], 1
    s_mov_b64 s[38:39], 0x10000001
    s_waitcnt lgkmcnt(1)
    v_add_f32 v97, v97, v98
    v_add_f32 v96, v96, v116
    v_cndmask_b32 v96, v96, v97, s[36:37]
    v_mul_f32 v96, 0.5, v96
    v_cndmask_b32 v116, v116, v96, s[38:39]
    v_pk_add_f32 v[116:117], v[116:117], v[68:69]
    v_pk_add_f32 v[118:119], v[118:119], v[70:71]
    v_pk_add_f32 v[88:89], v[88:89], v[116:117]
    v_pk_fma_f32 v[90:91], v[116:117], v[116:117], v[90:91]
    v_pk_fma_f32 v[92:93], v[116:117], v[76:77], v[92:93]
    v_pk_add_f32 v[88:89], v[88:89], v[118:119]
    v_pk_fma_f32 v[90:91], v[118:119], v[118:119], v[90:91]
    v_pk_fma_f32 v[92:93], v[118:119], v[78:79], v[92:93]
    s_waitcnt lgkmcnt(0)
    v_pk_add_f32 v[120:121], v[120:121], v[72:73]
    v_pk_add_f32 v[122:123], v[122:123], v[74:75]
    v_pk_add_f32 v[88:89], v[88:89], v[120:121]
    v_pk_fma_f32 v[90:91], v[120:121], v[120:121], v[90:91]
    v_pk_fma_f32 v[92:93], v[120:121], v[80:81], v[92:93]
    v_pk_add_f32 v[88:89], v[88:89], v[122:123]
    v_pk_fma_f32 v[90:91], v[122:123], v[122:123], v[90:91]
    v_pk_fma_f32 v[92:93], v[122:123], v[82:83], v[92:93]
    s_mov_b32 exec_hi, -1
    v_add_f32 v88, v88, v89
    v_add_f32 v90, v90, v91
    v_add_f32 v92, v92, v93
    v_mov_b32 v4, v92
    v_permlane32_swap_b32 v88, v90
    s_nop 0
    v_permlane32_swap_b32 v92, v4
    v_add_f32 v88, v88, v90
    v_add_f32 v92, v92, v4
    s_nop 1
    v_permlane16_swap_b32 v88, v92
    v_add_f32 v88, v88, v92
    s_nop 1
    v_add_f32_dpp v88, v88, v88 row_ror:8 row_mask:0xf bank_mask:0xf
    s_nop 1
    v_add_f32_dpp v88, v88, v88 row_ror:4 row_mask:0xf bank_mask:0xf
    s_nop 1
    v_add_f32_dpp v88, v88, v88 row_ror:2 row_mask:0xf bank_mask:0xf
    s_nop 1
    v_add_f32_dpp v88, v88, v88 row_ror:1 row_mask:0xf bank_mask:0xf
    s_nop 0
    v_readlane_b32 s37, v88, 0
    v_readlane_b32 s39, v88, 16
    v_readlane_b32 s38, v88, 32
    v_mov_b32 v97, 0x3b124925
    v_mul_f32 v96, s37, v97
    v_mul_f32 v97, s38, v97
    v_mov_b32 v156, s39
    v_fma_f32 v97, -v96, v96, v97
    v_fma_f32 v156, -v96, s58, v156
    v_max_f32 v98, 0, v97
    v_add_f32 v97, 0x3727c5ac, v98
    v_rsq_f32 v100, v97
    s_lshl_b32 s34, s20, 2
    v_mov_b32 v6, s34
    v_mul_f32 v156, v156, v100
    v_cvt_pk_bf16_f32 v156, v156, v156
    v_ashrrev_i32 v4, 31, v156
    v_or_b32 v4, 0x80000000, v4
    v_xor_b32 v156, v156, v4
    v_and_b32 v156, 0xffff0000, v156
    v_or_b32 v156, s32, v156
    ds_write_b32 v6, v156 offset:17152
    v_mov_b32 v159, 0xffff
    v_lshlrev_b32 v5, 2, v1
    v_mov_b32 v6, 17152
    s_waitcnt lgkmcnt(0)
    s_barrier
    s_cmp_lg_u32 s20, 0
    s_cbranch_scc1 Lnokey
    s_mov_b64 exec, 0xff
    ds_read_b32 v4, v5 offset:17152
    s_waitcnt lgkmcnt(0)
    v_bfi_b32 v4, v159, s59, v4
    buffer_store_dword v4, v5, s[12:15], s27 offen sc1
    s_mov_b64 exec, -1
Lnokey:
    ds_read_b128 v[52:55], v6
    ds_read_b128 v[56:59], v6 offset:16
    v_cvt_pk_bf16_f32 v98, v98, v98
    v_and_b32 v98, 0xffff0000, v98
    v_add_f32 v98, 0x3727c5ac, v98
    v_cvt_pk_bf16_f32 v98, v98, v98
    v_and_b32 v98, 0xffff0000, v98
    v_sqrt_f32 v98, v98
    s_nop 0
    v_cvt_pk_bf16_f32 v98, v98, v98
    v_and_b32 v98, 0xffff0000, v98
    v_rcp_f32 v100, v98
    s_nop 0
    v_mul_f32 v102, -v96, v100
    v_pk_fma_f32 v[68:69], v[116:117], v[100:101], v[102:103] op_sel_hi:[1,0,0]
    v_pk_fma_f32 v[70:71], v[118:119], v[100:101], v[102:103] op_sel_hi:[1,0,0]
    v_pk_fma_f32 v[72:73], v[120:121], v[100:101], v[102:103] op_sel_hi:[1,0,0]
    v_pk_fma_f32 v[74:75], v[122:123], v[100:101], v[102:103] op_sel_hi:[1,0,0]
    v_pk_add_f32 v[116:117], v[116:117], v[68:69]
    v_pk_add_f32 v[118:119], v[118:119], v[70:71]
    v_pk_add_f32 v[120:121], v[120:121], v[72:73]
    v_pk_add_f32 v[122:123], v[122:123], v[74:75]
    v_cvt_pk_bf16_f32 v164, v68, v69
    v_cvt_pk_bf16_f32 v160, v116, v117
    v_cvt_pk_bf16_f32 v165, v70, v71
    v_cvt_pk_bf16_f32 v161, v118, v119
    v_cvt_pk_bf16_f32 v166, v72, v73
    v_cvt_pk_bf16_f32 v162, v120, v121
    v_cvt_pk_bf16_f32 v167, v74, v75
    v_cvt_pk_bf16_f32 v163, v122, v123
    s_waitcnt lgkmcnt(0)
    v_max3_u32 v4, v52, v53, v54
    v_max3_u32 v5, v55, v56, v57
    v_max3_u32 v4, v4, v58, v59
    v_max_u32 v4, v4, v5
    v_cmp_eq_u32 s[60:61], v4, v156
    s_cmp_eq_u64 s[60:61], 0
    s_cbranch_scc1 Lnoeager
    s_lshl_b32 s34, s96, 11
    s_add_u32 s34, s34, 4194304
    v_mov_b32 v4, 0
    v_mov_b32 v5, 0
    v_writelane_b32 v164, 0, 56
    v_writelane_b32 v160, 0, 56
    s_mov_b32 exec_hi, 0x01ffffff
    v_add3_u32 v4, v164, v165, v166
    v_add3_u32 v5, v160, v161, v162
    v_add_u32 v4, v4, v167
    v_add_u32 v5, v5, v163
    s_mov_b32 exec_hi, -1
    v_add_u32_dpp v4, v4, v4 row_ror:8 row_mask:0xf bank_mask:0xf
    s_nop 1
    v_add_u32_dpp v4, v4, v4 row_ror:4 row_mask:0xf bank_mask:0xf
    s_nop 1
    v_add_u32_dpp v4, v4, v4 row_ror:2 row_mask:0xf bank_mask:0xf
    s_nop 1
    v_add_u32_dpp v4, v4, v4 row_ror:1 row_mask:0xf bank_mask:0xf
    s_nop 0
    v_readlane_b32 s36, v4, 0
    v_readlane_b32 s37, v4, 16
    v_readlane_b32 s38, v4, 32
    v_readlane_b32 s39, v4, 48
    s_add_u32 s36, s36, s37
    s_add_u32 s38, s38, s39
    s_add_u32 s36, s36, s38
    s_sub_u32 s35, s98, s36
    v_writelane_b32 v164, s35, 56
    v_add_u32_dpp v5, v5, v5 row_ror:8 row_mask:0xf bank_mask:0xf
    s_nop 1
    v_add_u32_dpp v5, v5, v5 row_ror:4 row_mask:0xf bank_mask:0xf
    s_nop 1
    v_add_u32_dpp v5, v5, v5 row_ror:2 row_mask:0xf bank_mask:0xf
    s_nop 1
    v_add_u32_dpp v5, v5, v5 row_ror:1 row_mask:0xf bank_mask:0xf
    s_nop 0
    v_readlane_b32 s36, v5, 0
    v_readlane_b32 s37, v5, 16
    v_readlane_b32 s38, v5, 32
    v_readlane_b32 s39, v5, 48
    s_add_u32 s36, s36, s37
    s_add_u32 s38, s38, s39
    s_add_u32 s36, s36, s38
    s_sub_u32 s35, s98, s36
    v_writelane_b32 v160, s35, 56
    s_mov_b32 exec_hi, 0x01ffffff
    buffer_store_dwordx4 v[164:167], v7, s[12:15], s34 offen sc1
    buffer_store_dwordx4 v[160:163], v7, s[12:15], s34 offen offset:1024 sc1
    s_mov_b32 exec_hi, -1
Lnoeager:
    s_cmp_lt_u32 s2, 224
    s_cbranch_scc1 Lnwd1
    s_and_b32 s50, s2, 7
    s_cmp_eq_u32 s50, 7
    s_cbranch_scc1 Lnwd1
    s_lshl_b32 s50, s50, 7
    s_bfe_u32 s51, s2, 0x20003
    s_lshl_b32 s51, s51, 5
    s_add_u32 s51, s51, s50
    s_mov_b32 s16, s46
    s_and_b32 s17, s47, 0xffff
    s_mov_b32 s18, 1605632
    s_mov_b32 s19, 0x00020000
    v_lshrrev_b32 v5, 1, v1
    v_mul_u32_u24 v5, 896, v5
    v_and_b32 v6, 1, v1
    v_lshl_add_u32 v5, v6, 4, v5
    s_mul_i32 s23, s20, 200704
    s_add_u32 s23, s23, s51
    s_add_u32 s23, s23, 0
    s_mul_i32 s25, s20, 7168
    s_add_u32 s25, s25, 99088
    s_mov_b32 m0, s25
    s_add_u32 s25, s25, 1024
    buffer_load_dwordx4 v5, s[16:19], s23 offen lds
    s_add_u32 s23, s23, 28672
    s_mov_b32 m0, s25
    s_add_u32 s25, s25, 1024
    buffer_load_dwordx4 v5, s[16:19], s23 offen lds
    s_add_u32 s23, s23, 28672
    s_mov_b32 m0, s25
    s_add_u32 s25, s25, 1024
    buffer_load_dwordx4 v5, s[16:19], s23 offen lds
    s_add_u32 s23, s23, 28672
    s_mov_b32 m0, s25
    s_add_u32 s25, s25, 1024
    buffer_load_dwordx4 v5, s[16:19], s23 offen lds
    s_add_u32 s23, s23, 28672
    s_mov_b32 m0, s25
    s_add_u32 s25, s25, 1024
    buffer_load_dwordx4 v5, s[16:19], s23 offen lds
    s_add_u32 s23, s23, 28672
    s_mov_b32 m0, s25
    s_add_u32 s25, s25, 1024
    buffer_load_dwordx4 v5, s[16:19], s23 offen lds
    s_add_u32 s23, s23, 28672
    s_mov_b32 m0, s25
    s_add_u32 s25, s25, 1024
    buffer_load_dwordx4 v5, s[16:19], s23 offen lds
    s_add_u32 s23, s23, 28672
Lnwd1:
    s_mov_b32 s34, 2228224
    v_mov_b32 v155, 0x7ff
    s_sleep 17
    s_mov_b32 s57, 4000000
Lpoll1:
    buffer_load_dwordx4 v[148:151], v47, s[12:15], s34 offen sc1
    s_waitcnt vmcnt(0)
    v_xor_b32 v4, v148, v149
    v_xor_b32 v5, v150, v151
    v_xor_b32 v6, s59, v148
    v_xor_b32 v157, s59, v150
    v_or3_b32 v4, v4, v5, v6
    v_bfi_b32 v148, v159, v224, v148
    v_bfi_b32 v149, v159, v225, v149
    v_bfi_b32 v150, v159, v226, v150
    v_bfi_b32 v151, v159, v227, v151
    v_or_b32 v4, v4, v157
    v_cmp_ne_u16 vcc, 0, v4
    s_cmp_eq_u64 vcc, 0
    s_cbranch_scc1 Lpoll1d
    s_sub_u32 s57, s57, 1
    s_cbranch_scc0 Lpoll1
Lpoll1d:
    v_max_u32 v152, v148, v149
    v_max_u32 v153, v150, v151
    v_max_u32 v157, v152, v153
    v_min_u32 v158, v152, v153
    s_nop 0
    v_mov_b32_dpp v154, v157 quad_perm:[1,0,3,2] row_mask:0xf bank_mask:0xf
    v_med3_u32 v157, v157, v154, v42
    v_min_u32 v152, v148, v149
    s_nop 0
    v_mov_b32_dpp v154, v157 quad_perm:[3,2,1,0] row_mask:0xf bank_mask:0xf
    v_med3_u32 v157, v157, v154, v43
    v_min_u32 v153, v150, v151
    s_nop 0
    v_mov_b32_dpp v154, v157 quad_perm:[1,0,3,2] row_mask:0xf bank_mask:0xf
    v_med3_u32 v157, v157, v154, v42
    v_max3_u32 v158, v158, v152, v153
    s_nop 0
    v_mov_b32_dpp v154, v157 row_half_mirror row_mask:0xf bank_mask:0xf
    v_med3_u32 v157, v157, v154, v44
    v_max_u32_dpp v158, v158, v158 row_ror:8 row_mask:0xf bank_mask:0xf
    s_nop 0
    v_mov_b32_dpp v154, v157 quad_perm:[2,3,0,1] row_mask:0xf bank_mask:0xf
    v_med3_u32 v157, v157, v154, v43
    v_max_u32_dpp v158, v158, v158 row_ror:4 row_mask:0xf bank_mask:0xf
    s_nop 0
    v_mov_b32_dpp v154, v157 quad_perm:[1,0,3,2] row_mask:0xf bank_mask:0xf
    v_med3_u32 v157, v157, v154, v42
    v_max_u32_dpp v158, v158, v158 row_ror:2 row_mask:0xf bank_mask:0xf
    s_nop 0
    v_max_u32_dpp v157, v157, v157 row_mirror row_mask:0xf bank_mask:0xf
    v_max_u32_dpp v158, v158, v158 row_ror:1 row_mask:0xf bank_mask:0xf
    s_nop 0
    v_max_u32_dpp v154, v157, v157 row_shl:4 row_mask:0xf bank_mask:0x5
    v_min_u32_dpp v154, v157, v157 row_shr:4 row_mask:0xf bank_mask:0xa
    v_mov_b32 v152, v158
    s_nop 0
    v_mov_b32_dpp v157, v154 quad_perm:[2,3,0,1] row_mask:0xf bank_mask:0xf
    v_med3_u32 v154, v154, v157, v43
    v_permlane16_swap_b32 v158, v152
    s_nop 0
    v_mov_b32_dpp v157, v154 quad_perm:[1,0,3,2] row_mask:0xf bank_mask:0xf
    v_med3_u32 v154, v154, v157, v42
    v_mov_b32 v157, v154
    v_max_u32 v158, v158, v152
    s_nop 0
    v_permlane16_swap_b32 v154, v157
    v_mov_b32 v152, v158
    s_nop 0
    v_max_u32_dpp v154, v157, v154 row_half_mirror row_mask:0xf bank_mask:0xf
    v_permlane32_swap_b32 v158, v152
    s_nop 0
    v_max_u32_dpp v157, v154, v154 row_shl:4 row_mask:0xf bank_mask:0x5
    v_min_u32_dpp v157, v154, v154 row_shr:4 row_mask:0xf bank_mask:0xa
    v_max_u32 v158, v158, v152
    s_nop 0
    v_mov_b32_dpp v154, v157 quad_perm:[2,3,0,1] row_mask:0xf bank_mask:0xf
    v_med3_u32 v157, v157, v154, v43
    s_mov_b64 vcc, 0x100
    s_nop 0
    v_mov_b32_dpp v154, v157 quad_perm:[1,0,3,2] row_mask:0xf bank_mask:0xf
    v_med3_u32 v157, v157, v154, v42
    v_mov_b32 v154, v157
    s_nop 1
    v_permlane32_swap_b32 v157, v154
    s_nop 1
    v_max_u32_dpp v157, v154, v157 row_half_mirror row_mask:0xf bank_mask:0xf
    s_nop 1
    v_max_u32_dpp v154, v157, v157 row_shl:4 row_mask:0xf bank_mask:0x5
    v_min_u32_dpp v154, v157, v157 row_shr:4 row_mask:0xf bank_mask:0xa
    s_nop 1
    v_mov_b32_dpp v157, v154 quad_perm:[2,3,0,1] row_mask:0xf bank_mask:0xf
    v_med3_u32 v154, v154, v157, v43
    s_nop 1
    v_mov_b32_dpp v157, v154 quad_perm:[1,0,3,2] row_mask:0xf bank_mask:0xf
    v_med3_u32 v154, v154, v157, v42
    s_mov_b64 exec, 0x1ff
    v_cndmask_b32 v152, v154, v158, vcc
    ds_write_b32 v48, v152
    s_mov_b32 exec_lo, 0x3030303
    s_mov_b32 exec_hi, 0x3030303
    v_bfi_b32 v153, v154, 0, v155
    v_lshl_add_u32 v153, v153, 11, v51
    buffer_load_dword v228, v153, s[12:15], s33 offen sc1
    s_mov_b64 exec, -1
    s_waitcnt lgkmcnt(0)
    s_barrier
    ds_read_b32 v157, v49
    ds_read_b32 v158, v50
    s_waitcnt lgkmcnt(0)
    v_max_u32_dpp v158, v158, v158 quad_perm:[1,0,3,2] row_mask:0xf bank_mask:0xf
    v_max_u32_dpp v157, v157, v157 row_mirror row_mask:0xf bank_mask:0xf
    s_nop 0
    v_max_u32_dpp v158, v158, v158 quad_perm:[2,3,0,1] row_mask:0xf bank_mask:0xf
    v_max_u32_dpp v154, v157, v157 row_shl:4 row_mask:0xf bank_mask:0x5
    v_min_u32_dpp v154, v157, v157 row_shr:4 row_mask:0xf bank_mask:0xa
    v_max_u32_dpp v158, v158, v158 row_half_mirror row_mask:0xf bank_mask:0xf
    s_nop 0
    v_mov_b32_dpp v157, v154 quad_perm:[2,3,0,1] row_mask:0xf bank_mask:0xf
    v_med3_u32 v154, v154, v157, v43
    s_nop 1
    v_mov_b32_dpp v157, v154 quad_perm:[1,0,3,2] row_mask:0xf bank_mask:0xf
    v_med3_u32 v154, v154, v157, v42
    v_mov_b32 v157, v154
    s_nop 1
    v_permlane16_swap_b32 v154, v157
    s_nop 1
    v_max_u32_dpp v154, v157, v154 row_half_mirror row_mask:0xf bank_mask:0xf
    s_nop 1
    v_max_u32_dpp v157, v154, v154 row_shl:4 row_mask:0xf bank_mask:0x5
    v_min_u32_dpp v157, v154, v154 row_shr:4 row_mask:0xf bank_mask:0xa
    s_nop 1
    v_mov_b32_dpp v154, v157 quad_perm:[2,3,0,1] row_mask:0xf bank_mask:0xf
    v_med3_u32 v157, v157, v154, v43
    s_nop 1
    v_mov_b32_dpp v154, v157 quad_perm:[1,0,3,2] row_mask:0xf bank_mask:0xf
    v_med3_u32 v157, v157, v154, v42
    v_mov_b32 v154, v157
    s_nop 1
    v_permlane32_swap_b32 v157, v154
    s_nop 1
    v_max_u32_dpp v157, v154, v157 row_half_mirror row_mask:0xf bank_mask:0xf
    v_cmp_gt_u32 vcc, v158, v157
    s_cmp_eq_u64 vcc, 0
    s_cbranch_scc0 Lfullsel
    v_mov_b32 v148, v157
Lseldone:
    v_cmp_eq_u32 vcc, v148, v156
    s_and_b64 s[62:63], vcc, s[60:61]
    s_cmp_lg_u64 s[62:63], vcc
    s_cbranch_scc0 Lsel_pub
    s_lshl_b32 s34, s96, 11
    s_add_u32 s34, s34, 4194304
    v_mov_b32 v4, 0
    v_mov_b32 v5, 0
    v_writelane_b32 v164, 0, 56
    v_writelane_b32 v160, 0, 56
    s_mov_b32 exec_hi, 0x01ffffff
    v_add3_u32 v4, v164, v165, v166
    v_add3_u32 v5, v160, v161, v162
    v_add_u32 v4, v4, v167
    v_add_u32 v5, v5, v163
    s_mov_b32 exec_hi, -1
    v_add_u32_dpp v4, v4, v4 row_ror:8 row_mask:0xf bank_mask:0xf
    s_nop 1
    v_add_u32_dpp v4, v4, v4 row_ror:4 row_mask:0xf bank_mask:0xf
    s_nop 1
    v_add_u32_dpp v4, v4, v4 row_ror:2 row_mask:0xf bank_mask:0xf
    s_nop 1
    v_add_u32_dpp v4, v4, v4 row_ror:1 row_mask:0xf bank_mask:0xf
    s_nop 0
    v_readlane_b32 s36, v4, 0
    v_readlane_b32 s37, v4, 16
    v_readlane_b32 s38, v4, 32
    v_readlane_b32 s39, v4, 48
    s_add_u32 s36, s36, s37
    s_add_u32 s38, s38, s39
    s_add_u32 s36, s36, s38
    s_sub_u32 s35, s98, s36
    v_writelane_b32 v164, s35, 56
    v_add_u32_dpp v5, v5, v5 row_ror:8 row_mask:0xf bank_mask:0xf
    s_nop 1
    v_add_u32_dpp v5, v5, v5 row_ror:4 row_mask:0xf bank_mask:0xf
    s_nop 1
    v_add_u32_dpp v5, v5, v5 row_ror:2 row_mask:0xf bank_mask:0xf
    s_nop 1
    v_add_u32_dpp v5, v5, v5 row_ror:1 row_mask:0xf bank_mask:0xf
    s_nop 0
    v_readlane_b32 s36, v5, 0
    v_readlane_b32 s37, v5, 16
    v_readlane_b32 s38, v5, 32
    v_readlane_b32 s39, v5, 48
    s_add_u32 s36, s36, s37
    s_add_u32 s38, s38, s39
    s_add_u32 s36, s36, s38
    s_sub_u32 s35, s98, s36
    v_writelane_b32 v160, s35, 56
    s_mov_b32 exec_hi, 0x01ffffff
    buffer_store_dwordx4 v[164:167], v7, s[12:15], s34 offen sc1
    buffer_store_dwordx4 v[160:163], v7, s[12:15], s34 offen offset:1024 sc1
    s_mov_b32 exec_hi, -1
Lsel_pub:
    v_readlane_b32 s34, v148, s20
    s_andn2_b32 s34, 0x7ff, s34
    s_lshl_b32 s34, s34, 11
    s_add_u32 s34, s34, s33
    s_mov_b32 exec_hi, 0x01ffffff
    s_nop 0
    buffer_load_dwordx4 v[84:87], v7, s[12:15], s34 offen sc1
    s_mov_b32 exec_hi, -1
    s_cmp_eq_u64 vcc, 0
    s_cbranch_scc0 Lsel_done
    s_mov_b32 exec_hi, 0x00ffffff
    buffer_store_dwordx4 v[160:163], v7, s[52:55], s97 offen
    s_mov_b32 exec_hi, -1
Lsel_done:
    s_cmp_ge_u32 s2, 224
    s_cbranch_scc1 Lc2
    s_cmp_lg_u32 s20, 0
    s_cbranch_scc1 Lc1_now
    v_lshrrev_b32 v4, 2, v2
    v_lshl_add_u32 v4, v3, 3, v4
    v_lshlrev_b32 v4, 4, v4
    v_and_b32 v5, 1, v2
    v_lshl_add_u32 v4, v5, 3, v4
    v_bfe_u32 v5, v2, 1, 1
    v_lshl_add_u32 v4, v5, 13, v4
    v_add_u32 v4, 99088, v4
    ds_read_b64_tr_b16 v[88:89], v4 offset:0
    ds_read_b64_tr_b16 v[90:91], v4 offset:64
    ds_read_b64_tr_b16 v[92:93], v4 offset:512
    ds_read_b64_tr_b16 v[94:95], v4 offset:576
    ds_read_b64_tr_b16 v[96:97], v4 offset:1024
    ds_read_b64_tr_b16 v[98:99], v4 offset:1088
    ds_read_b64_tr_b16 v[100:101], v4 offset:1536
    ds_read_b64_tr_b16 v[102:103], v4 offset:1600
    ds_read_b64_tr_b16 v[104:105], v4 offset:2048
    ds_read_b64_tr_b16 v[106:107], v4 offset:2112
    ds_read_b64_tr_b16 v[108:109], v4 offset:2560
    ds_read_b64_tr_b16 v[110:111], v4 offset:2624
    ds_read_b64_tr_b16 v[112:113], v4 offset:3072
    ds_read_b64_tr_b16 v[114:115], v4 offset:3136
    ds_read_b64_tr_b16 v[116:117], v4 offset:3584
    ds_read_b64_tr_b16 v[118:119], v4 offset:3648
    ds_read_b64_tr_b16 v[120:121], v4 offset:4096
    ds_read_b64_tr_b16 v[122:123], v4 offset:4160
    ds_read_b64_tr_b16 v[124:125], v4 offset:4608
    ds_read_b64_tr_b16 v[126:127], v4 offset:4672
    ds_read_b64_tr_b16 v[128:129], v4 offset:5120
    ds_read_b64_tr_b16 v[130:131], v4 offset:5184
    ds_read_b64_tr_b16 v[132:133], v4 offset:5632
    ds_read_b64_tr_b16 v[134:135], v4 offset:5696
    ds_read_b64_tr_b16 v[136:137], v4 offset:6144
    ds_read_b64_tr_b16 v[138:139], v4 offset:6208
    ds_read_b64_tr_b16 v[140:141], v4 offset:6656
    ds_read_b64_tr_b16 v[142:143], v4 offset:6720
    v_and_b32 v64, 7, v2
    v_mul_u32_u24 v64, 928, v64
    v_lshl_add_u32 v64, v3, 4, v64
    v_lshlrev_b32 v65, 4, v2
    v_lshl_add_u32 v65, v3, 3, v65
    s_lshl_b32 s22, s100, 7
    s_add_u32 s22, s22, 2162688
Lc1_now:
    s_mul_i32 s29, s20, 928
    s_add_u32 s29, s29, 17408
    v_add_u32 v6, s29, v7
    s_mov_b32 s57, 4000000
Lrow2:
    v_mov_b32 v4, 0
    s_mov_b32 exec_hi, 0x01ffffff
    s_waitcnt vmcnt(0)
    ds_write_b128 v6, v[84:87]
    v_add3_u32 v4, v84, v85, v86
    v_add_u32 v4, v4, v87
    s_mov_b32 exec_hi, -1
    s_nop 0
    v_add_u32_dpp v4, v4, v4 row_ror:8 row_mask:0xf bank_mask:0xf
    s_nop 1
    v_add_u32_dpp v4, v4, v4 row_ror:4 row_mask:0xf bank_mask:0xf
    s_nop 1
    v_add_u32_dpp v4, v4, v4 row_ror:2 row_mask:0xf bank_mask:0xf
    s_nop 1
    v_add_u32_dpp v4, v4, v4 row_ror:1 row_mask:0xf bank_mask:0xf
    s_nop 0
    v_readlane_b32 s36, v4, 0
    v_readlane_b32 s37, v4, 16
    v_readlane_b32 s38, v4, 32
    v_readlane_b32 s39, v4, 48
    s_add_u32 s36, s36, s37
    s_add_u32 s38, s38, s39
    s_add_u32 s36, s36, s38
    s_cmp_eq_u32 s36, s98
    s_cbranch_scc1 Lrow2d
    s_mov_b32 exec_hi, 0x01ffffff
    s_waitcnt lgkmcnt(0)
    buffer_load_dwordx4 v[84:87], v7, s[12:15], s34 offen sc1
    s_mov_b32 exec_hi, -1
    s_sub_u32 s57, s57, 1
    s_cbranch_scc0 Lrow2
Lrow2d:
    s_waitcnt lgkmcnt(0)
    s_barrier
    s_cmp_lg_u32 s20, 0
    s_cbranch_scc1 Lc1_epoch
    ds_read_b128 v[168:171], v64 offset:17408
    ds_read_b128 v[172:175], v64 offset:17472
    ds_read_b128 v[176:179], v64 offset:17536
    ds_read_b128 v[180:183], v64 offset:17600
    ds_read_b128 v[184:187], v64 offset:17664
    ds_read_b128 v[188:191], v64 offset:17728
    ds_read_b128 v[192:195], v64 offset:17792
    ds_read_b128 v[196:199], v64 offset:17856
    ds_read_b128 v[200:203], v64 offset:17920
    ds_read_b128 v[204:207], v64 offset:17984
    ds_read_b128 v[208:211], v64 offset:18048
    ds_read_b128 v[212:215], v64 offset:18112
    ds_read_b128 v[216:219], v64 offset:18176
    ds_read_b128 v[220:223], v64 offset:18240
    s_waitcnt lgkmcnt(13)
    v_mfma_f32_16x16x32_bf16 v[52:55], v[88:91], v[168:171], 0
    s_waitcnt lgkmcnt(12)
    v_mfma_f32_16x16x32_bf16 v[56:59], v[92:95], v[172:175], 0
    s_waitcnt lgkmcnt(11)
    v_mfma_f32_16x16x32_bf16 v[52:55], v[96:99], v[176:179], v[52:55]
    s_waitcnt lgkmcnt(10)
    v_mfma_f32_16x16x32_bf16 v[56:59], v[100:103], v[180:183], v[56:59]
    s_waitcnt lgkmcnt(9)
    v_mfma_f32_16x16x32_bf16 v[52:55], v[104:107], v[184:187], v[52:55]
    s_waitcnt lgkmcnt(8)
    v_mfma_f32_16x16x32_bf16 v[56:59], v[108:111], v[188:191], v[56:59]
    s_waitcnt lgkmcnt(7)
    v_mfma_f32_16x16x32_bf16 v[52:55], v[112:115], v[192:195], v[52:55]
    s_waitcnt lgkmcnt(6)
    v_mfma_f32_16x16x32_bf16 v[56:59], v[116:119], v[196:199], v[56:59]
    s_waitcnt lgkmcnt(5)
    v_mfma_f32_16x16x32_bf16 v[52:55], v[120:123], v[200:203], v[52:55]
    s_waitcnt lgkmcnt(4)
    v_mfma_f32_16x16x32_bf16 v[56:59], v[124:127], v[204:207], v[56:59]
    s_waitcnt lgkmcnt(3)
    v_mfma_f32_16x16x32_bf16 v[52:55], v[128:131], v[208:211], v[52:55]
    s_waitcnt lgkmcnt(2)
    v_mfma_f32_16x16x32_bf16 v[56:59], v[132:135], v[212:215], v[56:59]
    s_waitcnt lgkmcnt(1)
    v_mfma_f32_16x16x32_bf16 v[52:55], v[136:139], v[216:219], v[52:55]
    s_waitcnt lgkmcnt(0)
    v_mfma_f32_16x16x32_bf16 v[56:59], v[140:143], v[220:223], v[56:59]
    s_nop 7
    v_pk_add_f32 v[52:53], v[52:53], v[56:57]
    v_pk_add_f32 v[54:55], v[54:55], v[58:59]
    v_cvt_pk_bf16_f32 v56, v52, v53
    v_cvt_pk_bf16_f32 v57, v54, v55
    v_mov_b32 v58, v56
    v_mov_b32 v59, v57
    s_nop 0
    v_permlane32_swap_b32 v56, v58
    v_permlane32_swap_b32 v57, v59
    v_lshlrev_b32 v52, 16, v56
    v_and_b32 v53, 0xffff0000, v56
    v_lshlrev_b32 v54, 16, v57
    v_and_b32 v55, 0xffff0000, v57
    v_mul_f32 v60, 0xbfb8aa3b, v52
    v_mul_f32 v61, 0xbfb8aa3b, v53
    v_mul_f32 v62, 0xbfb8aa3b, v54
    v_mul_f32 v63, 0xbfb8aa3b, v55
    v_exp_f32 v60, v60
    v_exp_f32 v61, v61
    v_exp_f32 v62, v62
    v_exp_f32 v63, v63
    v_lshlrev_b32 v84, 16, v58
    v_and_b32 v85, 0xffff0000, v58
    v_lshlrev_b32 v86, 16, v59
    v_and_b32 v87, 0xffff0000, v59
    v_add_f32 v60, 1.0, v60
    v_add_f32 v61, 1.0, v61
    v_add_f32 v62, 1.0, v62
    v_add_f32 v63, 1.0, v63
    v_rcp_f32 v60, v60
    v_rcp_f32 v61, v61
    v_rcp_f32 v62, v62
    v_rcp_f32 v63, v63
    v_mul_f32 v52, v52, v60
    v_mul_f32 v53, v53, v61
    v_mul_f32 v54, v54, v62
    v_mul_f32 v55, v55, v63
    v_cvt_pk_bf16_f32 v56, v52, v53
    v_cvt_pk_bf16_f32 v57, v54, v55
    v_lshlrev_b32 v52, 16, v56
    v_and_b32 v53, 0xffff0000, v56
    v_lshlrev_b32 v54, 16, v57
    v_and_b32 v55, 0xffff0000, v57
    v_pk_mul_f32 v[52:53], v[52:53], v[84:85]
    v_pk_mul_f32 v[54:55], v[54:55], v[86:87]
    v_cvt_pk_bf16_f32 v84, v52, v53
    v_cvt_pk_bf16_f32 v85, v54, v55
    v_min_u32 v84, -2, v84
    v_min_u32 v85, -2, v85
    s_mov_b32 exec_lo, 0x00ff00ff
    s_mov_b32 exec_hi, 0
    buffer_store_dwordx2 v[84:85], v65, s[12:15], s22 offen sc1
    s_branch Lend
Lc1_epoch:
    s_lshl_b32 s29, s2, 3
    s_add_u32 s29, s29, s20
    s_cmp_lg_u32 s29, 1
    s_cbranch_scc1 Lend
    s_mov_b64 exec, 1
    v_mov_b32 v4, s56
    s_mov_b32 s29, 2129920
    buffer_store_dword v4, v7, s[12:15], s29 offen sc1
    s_branch Lend
Lc2:
    s_and_b32 s50, s2, 7
    s_cmp_eq_u32 s50, 7
    s_cbranch_scc1 Lend
    s_lshl_b32 s50, s50, 7
    s_bfe_u32 s51, s2, 0x20003
    s_lshl_b32 s51, s51, 5
    s_add_u32 s51, s51, s50
    s_mul_i32 s24, s20, 7168
    s_add_u32 s24, s24, 99088
    v_lshrrev_b32 v4, 2, v2
    v_lshl_add_u32 v4, v3, 3, v4
    v_lshlrev_b32 v4, 5, v4
    v_and_b32 v5, 3, v2
    v_lshl_add_u32 v4, v5, 3, v4
    v_add_u32 v15, s24, v4
    ds_read_b64_tr_b16 v[88:89], v15 offset:0
    ds_read_b64_tr_b16 v[90:91], v15 offset:128
    ds_read_b64_tr_b16 v[92:93], v15 offset:1024
    ds_read_b64_tr_b16 v[94:95], v15 offset:1152
    ds_read_b64_tr_b16 v[96:97], v15 offset:2048
    ds_read_b64_tr_b16 v[98:99], v15 offset:2176
    ds_read_b64_tr_b16 v[100:101], v15 offset:3072
    ds_read_b64_tr_b16 v[102:103], v15 offset:3200
    ds_read_b64_tr_b16 v[104:105], v15 offset:4096
    ds_read_b64_tr_b16 v[106:107], v15 offset:4224
    ds_read_b64_tr_b16 v[108:109], v15 offset:5120
    ds_read_b64_tr_b16 v[110:111], v15 offset:5248
    ds_read_b64_tr_b16 v[112:113], v15 offset:6144
    ds_read_b64_tr_b16 v[114:115], v15 offset:6272
    v_and_b32 v5, 7, v2
    v_mul_u32_u24 v14, 928, v5
    v_lshl_add_u32 v14, v3, 3, v14
    v_add_u32 v14, s51, v14
    v_lshlrev_b32 v13, 4, v5
    v_lshl_add_u32 v13, v3, 7, v13
    s_mul_i32 s25, s20, 3584
    s_add_u32 s25, s25, 2162688
    v_and_b32 v8, 0x7ff, v148
    v_sub_u32 v8, 2047, v8
    v_mul_u32_u24 v8, 896, v8
    v_lshl_add_u32 v8, v3, 3, v8
    v_ashrrev_i32 v6, 31, v148
    v_not_b32 v6, v6
    v_or_b32 v6, 0x80000000, v6
    v_xor_b32 v149, v148, v6
    v_and_b32 v149, 0xffff0000, v149
    v_mul_f32 v6, 0xbfb8aa3b, v149
    v_exp_f32 v6, v6
    s_nop 0
    v_add_f32 v6, 1.0, v6
    v_rcp_f32 v6, v6
    s_nop 0
    v_mul_f32 v12, 1.0, v6
    v_cvt_pk_bf16_f32 v12, v12, v12
    v_and_b32 v12, 0xffff0000, v12
    v_lshlrev_b32 v5, 4, v0
    v_add_u32 v5, 24832, v5
    s_sleep 4
    buffer_load_dwordx4 v[116:119], v13, s[12:15], s25 offen offset:0 sc1
    buffer_load_dwordx4 v[120:123], v13, s[12:15], s25 offen offset:512 sc1
    buffer_load_dwordx4 v[124:127], v13, s[12:15], s25 offen offset:1024 sc1
    buffer_load_dwordx4 v[128:131], v13, s[12:15], s25 offen offset:1536 sc1
    buffer_load_dwordx4 v[132:135], v13, s[12:15], s25 offen offset:2048 sc1
    buffer_load_dwordx4 v[136:139], v13, s[12:15], s25 offen offset:2560 sc1
    buffer_load_dwordx4 v[140:143], v13, s[12:15], s25 offen offset:3072 sc1
    s_mov_b64 exec, -1
    s_mul_i32 s29, s20, 928
    s_add_u32 s29, s29, 17408
    v_add_u32 v6, s29, v7
    s_mov_b32 s57, 4000000
Lrow3:
    v_mov_b32 v4, 0
    s_mov_b32 exec_hi, 0x01ffffff
    s_waitcnt vmcnt(0)
    ds_write_b128 v6, v[84:87]
    v_add3_u32 v4, v84, v85, v86
    v_add_u32 v4, v4, v87
    s_mov_b32 exec_hi, -1
    s_nop 0
    v_add_u32_dpp v4, v4, v4 row_ror:8 row_mask:0xf bank_mask:0xf
    s_nop 1
    v_add_u32_dpp v4, v4, v4 row_ror:4 row_mask:0xf bank_mask:0xf
    s_nop 1
    v_add_u32_dpp v4, v4, v4 row_ror:2 row_mask:0xf bank_mask:0xf
    s_nop 1
    v_add_u32_dpp v4, v4, v4 row_ror:1 row_mask:0xf bank_mask:0xf
    s_nop 0
    v_readlane_b32 s36, v4, 0
    v_readlane_b32 s37, v4, 16
    v_readlane_b32 s38, v4, 32
    v_readlane_b32 s39, v4, 48
    s_add_u32 s36, s36, s37
    s_add_u32 s38, s38, s39
    s_add_u32 s36, s36, s38
    s_cmp_eq_u32 s36, s98
    s_cbranch_scc1 Lrow3d
    s_mov_b32 exec_hi, 0x01ffffff
    s_waitcnt lgkmcnt(0)
    buffer_load_dwordx4 v[84:87], v7, s[12:15], s34 offen sc1
    s_mov_b32 exec_hi, -1
    s_sub_u32 s57, s57, 1
    s_cbranch_scc0 Lrow3
Lrow3d:
    v_max_u32 v4, v116, v117
    v_max3_u32 v4, v4, v118, v119
    v_max3_u32 v4, v4, v120, v121
    v_max3_u32 v4, v4, v122, v123
    v_max3_u32 v4, v4, v124, v125
    v_max3_u32 v4, v4, v126, v127
    v_max3_u32 v4, v4, v128, v129
    v_max3_u32 v4, v4, v130, v131
    v_max3_u32 v4, v4, v132, v133
    v_max3_u32 v4, v4, v134, v135
    v_max3_u32 v4, v4, v136, v137
    v_max3_u32 v4, v4, v138, v139
    v_max3_u32 v4, v4, v140, v141
    v_max3_u32 v4, v4, v142, v143
    v_cmp_eq_u32 vcc, -1, v4
    s_cmp_eq_u64 vcc, 0
    s_cbranch_scc1 Lactok
    s_mov_b32 s57, 4000000
Lpoll4:
    buffer_load_dwordx4 v[116:119], v13, s[12:15], s25 offen offset:0 sc1
    buffer_load_dwordx4 v[120:123], v13, s[12:15], s25 offen offset:512 sc1
    buffer_load_dwordx4 v[124:127], v13, s[12:15], s25 offen offset:1024 sc1
    buffer_load_dwordx4 v[128:131], v13, s[12:15], s25 offen offset:1536 sc1
    buffer_load_dwordx4 v[132:135], v13, s[12:15], s25 offen offset:2048 sc1
    buffer_load_dwordx4 v[136:139], v13, s[12:15], s25 offen offset:2560 sc1
    buffer_load_dwordx4 v[140:143], v13, s[12:15], s25 offen offset:3072 sc1
    s_waitcnt vmcnt(0)
    v_max_u32 v4, v116, v117
    v_max3_u32 v4, v4, v118, v119
    v_max3_u32 v4, v4, v120, v121
    v_max3_u32 v4, v4, v122, v123
    v_max3_u32 v4, v4, v124, v125
    v_max3_u32 v4, v4, v126, v127
    v_max3_u32 v4, v4, v128, v129
    v_max3_u32 v4, v4, v130, v131
    v_max3_u32 v4, v4, v132, v133
    v_max3_u32 v4, v4, v134, v135
    v_max3_u32 v4, v4, v136, v137
    v_max3_u32 v4, v4, v138, v139
    v_max3_u32 v4, v4, v140, v141
    v_max3_u32 v4, v4, v142, v143
    v_cmp_eq_u32 vcc, -1, v4
    s_cmp_eq_u64 vcc, 0
    s_cbranch_scc1 Lpoll4d
    s_sub_u32 s57, s57, 1
    s_cbranch_scc0 Lpoll4
Lpoll4d:
Lactok:
    s_mov_b64 exec, -1
    s_waitcnt lgkmcnt(0)
    v_mfma_f32_16x16x32_bf16 v[52:55], v[88:91], v[116:119], 0
    v_mfma_f32_16x16x32_bf16 v[56:59], v[92:95], v[120:123], 0
    v_mfma_f32_16x16x32_bf16 v[52:55], v[96:99], v[124:127], v[52:55]
    v_mfma_f32_16x16x32_bf16 v[56:59], v[100:103], v[128:131], v[56:59]
    v_mfma_f32_16x16x32_bf16 v[52:55], v[104:107], v[132:135], v[52:55]
    v_mfma_f32_16x16x32_bf16 v[56:59], v[108:111], v[136:139], v[56:59]
    v_mfma_f32_16x16x32_bf16 v[52:55], v[112:115], v[140:143], v[52:55]
    s_nop 7
    v_pk_add_f32 v[52:53], v[52:53], v[56:57]
    v_pk_add_f32 v[54:55], v[54:55], v[58:59]
    ds_write_b128 v5, v[52:55]
    s_waitcnt lgkmcnt(0)
    s_barrier
    s_cmp_lg_u32 s20, 0
    s_cbranch_scc1 Lend
    ds_read_b64 v[10:11], v14 offset:17408
    ds_read_b128 v[172:175], v5 offset:1024
    ds_read_b128 v[176:179], v5 offset:2048
    ds_read_b128 v[180:183], v5 offset:3072
    ds_read_b128 v[184:187], v5 offset:4096
    ds_read_b128 v[188:191], v5 offset:5120
    ds_read_b128 v[192:195], v5 offset:6144
    ds_read_b128 v[196:199], v5 offset:7168
    s_waitcnt lgkmcnt(7)
    v_lshlrev_b32 v168, 16, v10
    v_and_b32 v169, 0xffff0000, v10
    v_lshlrev_b32 v170, 16, v11
    v_and_b32 v171, 0xffff0000, v11
    s_waitcnt lgkmcnt(6)
    v_pk_add_f32 v[52:53], v[52:53], v[172:173]
    v_pk_add_f32 v[54:55], v[54:55], v[174:175]
    s_waitcnt lgkmcnt(5)
    v_pk_add_f32 v[52:53], v[52:53], v[176:177]
    v_pk_add_f32 v[54:55], v[54:55], v[178:179]
    s_waitcnt lgkmcnt(4)
    v_pk_add_f32 v[52:53], v[52:53], v[180:181]
    v_pk_add_f32 v[54:55], v[54:55], v[182:183]
    s_waitcnt lgkmcnt(3)
    v_pk_add_f32 v[52:53], v[52:53], v[184:185]
    v_pk_add_f32 v[54:55], v[54:55], v[186:187]
    s_waitcnt lgkmcnt(2)
    v_pk_add_f32 v[52:53], v[52:53], v[188:189]
    v_pk_add_f32 v[54:55], v[54:55], v[190:191]
    s_waitcnt lgkmcnt(1)
    v_pk_add_f32 v[52:53], v[52:53], v[192:193]
    v_pk_add_f32 v[54:55], v[54:55], v[194:195]
    s_waitcnt lgkmcnt(0)
    v_pk_add_f32 v[52:53], v[52:53], v[196:197]
    v_pk_add_f32 v[54:55], v[54:55], v[198:199]
    v_cvt_pk_bf16_f32 v56, v52, v53
    v_cvt_pk_bf16_f32 v57, v54, v55
    v_lshlrev_b32 v52, 16, v56
    v_and_b32 v53, 0xffff0000, v56
    v_lshlrev_b32 v54, 16, v57
    v_and_b32 v55, 0xffff0000, v57
    v_pk_mul_f32 v[52:53], v[52:53], v[12:13] op_sel_hi:[1,0]
    v_pk_mul_f32 v[54:55], v[54:55], v[12:13] op_sel_hi:[1,0]
    v_cvt_pk_bf16_f32 v56, v52, v53
    v_cvt_pk_bf16_f32 v57, v54, v55
    v_lshlrev_b32 v52, 16, v56
    v_and_b32 v53, 0xffff0000, v56
    v_lshlrev_b32 v54, 16, v57
    v_and_b32 v55, 0xffff0000, v57
    v_pk_add_f32 v[52:53], v[52:53], v[168:169]
    v_pk_add_f32 v[54:55], v[54:55], v[170:171]
    v_cvt_pk_bf16_f32 v10, v52, v53
    v_cvt_pk_bf16_f32 v11, v54, v55
    s_mov_b32 exec_lo, 0x00ff00ff
    s_mov_b32 exec_hi, 0x00ff00ff
    buffer_store_dwordx2 v[10:11], v8, s[52:55], s51 offen
Lend:
    s_endpgm
Lltail:
    s_mov_b64 exec, -1
    s_load_dwordx2 s[6:7], s[0:1], 96
    s_load_dwordx8 s[40:47], s[0:1], 48
    s_load_dwordx2 s[48:49], s[0:1], 80
    v_and_b32 v2, 15, v0
    v_bfe_u32 v3, v0, 4, 2
    s_waitcnt vmcnt(8)
    s_barrier
    s_waitcnt lgkmcnt(0)
    s_mov_b32 s12, s6
    s_and_b32 s13, s7, 0xffff
    s_mov_b32 s14, 8388608
    s_mov_b32 s15, 0x00020000
    s_mov_b32 s52, s48
    s_and_b32 s53, s49, 0xffff
    s_mov_b32 s54, 1835008
    s_mov_b32 s55, 0x00020000
    s_mov_b32 s16, s40
    s_and_b32 s17, s41, 0xffff
    s_mov_b32 s18, 896
    s_mov_b32 s19, 0x00020000
    s_and_b32 s92, s2, 7
    s_lshr_b32 s93, s2, 6
    s_lshl_b32 s93, s93, 3
    s_or_b32 s92, s92, s93
    s_bfe_u32 s93, s2, 0x10003
    s_bfe_u32 s96, s2, 0x20004
    s_sub_u32 s95, 64, s92
    s_cmp_eq_u32 s92, 0
    s_cselect_b32 s95, 32, s95
    s_cselect_b32 s94, 0, 1
    s_xor_b32 s94, s94, s93
    s_cmp_eq_u32 s93, 0
    s_cselect_b32 s95, s92, s95
    s_lshl_b32 s96, s96, 9
    s_add_u32 s95, s95, s96
    s_lshl_b32 s96, s20, 6
    s_add_u32 s96, s96, s95
    s_mul_i32 s97, s96, 896
    s_mov_b32 s26, 2129920
    v_mov_b32 v4, 0
    buffer_load_dword v16, v4, s[12:15], s26 offen sc1
    buffer_load_dwordx4 v[12:15], v7, s[16:19], 0 offen
    buffer_load_dwordx4 v[8:11], v7, s[8:11], s97 offen
    s_cmp_lg_u32 s20, 0
    s_cbranch_scc1 Lw123a
    v_mov_b32 v230, -1
    v_lshlrev_b32 v5, 2, v1
    s_lshl_b32 s24, s2, 7
    s_add_u32 s24, s24, 2162688
    s_mov_b32 exec_hi, 0
    buffer_store_dword v230, v5, s[12:15], s24 offen sc1
    s_mov_b32 exec_lo, 1
    s_lshl_b32 s23, s96, 11
    s_add_u32 s23, s23, 4194304
    buffer_load_dword v228, v7, s[52:55], s97 offen
    buffer_load_dword v229, v7, s[12:15], s23 offen
    s_mov_b64 exec, -1
    s_waitcnt vmcnt(6)
    s_barrier
    v_mov_b32 v4, 90368
    s_waitcnt vmcnt(5)
    ds_write_b32 v4, v16
    s_branch Lprol
Lw123a:
    s_and_b32 s24, s2, 7
    s_lshr_b32 s25, s2, 3
    s_mul_i32 s26, s25, 50176
    s_mov_b32 s18, 1605632
    s_mov_b32 s19, 0x00020000
    s_cmp_eq_u32 s20, 3
    s_cbranch_scc1 Lpf_d
    v_lshrrev_b32 v4, 2, v1
    v_mul_u32_u24 v4, 3584, v4
    v_and_b32 v5, 3, v1
    v_lshl_add_u32 v4, v5, 7, v4
    s_mul_i32 s24, s24, 448
    s_cmp_eq_u32 s20, 1
    s_cselect_b32 s16, s42, s44
    s_cselect_b32 s17, s43, s45
    s_branch Lpf_go
Lpf_d:
    v_mul_u32_u24 v4, 896, v1
    s_lshl_b32 s24, s24, 7
    s_mov_b32 s16, s46
    s_mov_b32 s17, s47
Lpf_go:
    s_and_b32 s17, s17, 0xffff
    s_add_u32 s26, s26, s24
    s_mov_b32 exec_hi, 0x00ffffff
    buffer_load_dword v228, v4, s[16:19], s26 offen
    s_mov_b32 exec_hi, -1
    s_waitcnt vmcnt(4)
    s_barrier
    s_waitcnt vmcnt(3)
Lprol:
    s_waitcnt lgkmcnt(0)
    s_barrier
    s_branch Lpro1
Lexit:
    s_endpgm
Lfullsel:
    v_mov_b32_dpp v152, v148 quad_perm:[1,0,3,2] row_mask:0xf bank_mask:0xf
    v_mov_b32_dpp v153, v149 quad_perm:[1,0,3,2] row_mask:0xf bank_mask:0xf
    v_mov_b32_dpp v154, v150 quad_perm:[1,0,3,2] row_mask:0xf bank_mask:0xf
    v_mov_b32_dpp v155, v151 quad_perm:[1,0,3,2] row_mask:0xf bank_mask:0xf
    v_med3_u32 v148, v148, v152, v42
    v_med3_u32 v149, v149, v153, v42
    v_med3_u32 v150, v150, v154, v42
    v_med3_u32 v151, v151, v155, v42
    v_mov_b32_dpp v152, v148 quad_perm:[3,2,1,0] row_mask:0xf bank_mask:0xf
    v_mov_b32_dpp v153, v149 quad_perm:[3,2,1,0] row_mask:0xf bank_mask:0xf
    v_mov_b32_dpp v154, v150 quad_perm:[3,2,1,0] row_mask:0xf bank_mask:0xf
    v_mov_b32_dpp v155, v151 quad_perm:[3,2,1,0] row_mask:0xf bank_mask:0xf
    v_med3_u32 v148, v148, v152, v43
    v_med3_u32 v149, v149, v153, v43
    v_med3_u32 v150, v150, v154, v43
    v_med3_u32 v151, v151, v155, v43
    v_mov_b32_dpp v152, v148 quad_perm:[1,0,3,2] row_mask:0xf bank_mask:0xf
    v_mov_b32_dpp v153, v149 quad_perm:[1,0,3,2] row_mask:0xf bank_mask:0xf
    v_mov_b32_dpp v154, v150 quad_perm:[1,0,3,2] row_mask:0xf bank_mask:0xf
    v_mov_b32_dpp v155, v151 quad_perm:[1,0,3,2] row_mask:0xf bank_mask:0xf
    v_med3_u32 v148, v148, v152, v42
    v_med3_u32 v149, v149, v153, v42
    v_med3_u32 v150, v150, v154, v42
    v_med3_u32 v151, v151, v155, v42
    v_mov_b32_dpp v152, v148 row_half_mirror row_mask:0xf bank_mask:0xf
    v_mov_b32_dpp v153, v149 row_half_mirror row_mask:0xf bank_mask:0xf
    v_mov_b32_dpp v154, v150 row_half_mirror row_mask:0xf bank_mask:0xf
    v_mov_b32_dpp v155, v151 row_half_mirror row_mask:0xf bank_mask:0xf
    v_med3_u32 v148, v148, v152, v44
    v_med3_u32 v149, v149, v153, v44
    v_med3_u32 v150, v150, v154, v44
    v_med3_u32 v151, v151, v155, v44
    v_mov_b32_dpp v152, v148 quad_perm:[2,3,0,1] row_mask:0xf bank_mask:0xf
    v_mov_b32_dpp v153, v149 quad_perm:[2,3,0,1] row_mask:0xf bank_mask:0xf
    v_mov_b32_dpp v154, v150 quad_perm:[2,3,0,1] row_mask:0xf bank_mask:0xf
    v_mov_b32_dpp v155, v151 quad_perm:[2,3,0,1] row_mask:0xf bank_mask:0xf
    v_med3_u32 v148, v148, v152, v43
    v_med3_u32 v149, v149, v153, v43
    v_med3_u32 v150, v150, v154, v43
    v_med3_u32 v151, v151, v155, v43
    v_mov_b32_dpp v152, v148 quad_perm:[1,0,3,2] row_mask:0xf bank_mask:0xf
    v_mov_b32_dpp v153, v149 quad_perm:[1,0,3,2] row_mask:0xf bank_mask:0xf
    v_mov_b32_dpp v154, v150 quad_perm:[1,0,3,2] row_mask:0xf bank_mask:0xf
    v_mov_b32_dpp v155, v151 quad_perm:[1,0,3,2] row_mask:0xf bank_mask:0xf
    v_med3_u32 v148, v148, v152, v42
    v_med3_u32 v149, v149, v153, v42
    v_med3_u32 v150, v150, v154, v42
    v_med3_u32 v151, v151, v155, v42
    v_max_u32_dpp v148, v149, v148 row_half_mirror row_mask:0xf bank_mask:0xf
    s_nop 0
    v_max_u32_dpp v150, v151, v150 row_half_mirror row_mask:0xf bank_mask:0xf
    v_max_u32_dpp v152, v148, v148 row_shl:4 row_mask:0xf bank_mask:0x5
    v_min_u32_dpp v152, v148, v148 row_shr:4 row_mask:0xf bank_mask:0xa
    v_max_u32_dpp v153, v150, v150 row_shl:4 row_mask:0xf bank_mask:0x5
    v_min_u32_dpp v153, v150, v150 row_shr:4 row_mask:0xf bank_mask:0xa
    v_mov_b32 v148, v152
    v_mov_b32 v150, v153
    s_nop 0
    v_mov_b32_dpp v152, v148 quad_perm:[2,3,0,1] row_mask:0xf bank_mask:0xf
    v_mov_b32_dpp v153, v150 quad_perm:[2,3,0,1] row_mask:0xf bank_mask:0xf
    v_med3_u32 v148, v148, v152, v43
    v_med3_u32 v150, v150, v153, v43
    s_nop 0
    v_mov_b32_dpp v152, v148 quad_perm:[1,0,3,2] row_mask:0xf bank_mask:0xf
    v_mov_b32_dpp v153, v150 quad_perm:[1,0,3,2] row_mask:0xf bank_mask:0xf
    v_med3_u32 v148, v148, v152, v42
    v_med3_u32 v150, v150, v153, v42
    s_nop 1
    v_max_u32_dpp v148, v150, v148 row_half_mirror row_mask:0xf bank_mask:0xf
    s_nop 1
    v_max_u32_dpp v152, v148, v148 row_shl:4 row_mask:0xf bank_mask:0x5
    v_min_u32_dpp v152, v148, v148 row_shr:4 row_mask:0xf bank_mask:0xa
    v_mov_b32 v148, v152
    s_nop 1
    v_mov_b32_dpp v152, v148 quad_perm:[2,3,0,1] row_mask:0xf bank_mask:0xf
    v_med3_u32 v148, v148, v152, v43
    s_nop 1
    v_mov_b32_dpp v152, v148 quad_perm:[1,0,3,2] row_mask:0xf bank_mask:0xf
    v_med3_u32 v148, v148, v152, v42
    s_nop 1
    v_max_u32_dpp v148, v148, v148 row_mirror row_mask:0xf bank_mask:0xf
    s_nop 1
    v_max_u32_dpp v152, v148, v148 row_shl:4 row_mask:0xf bank_mask:0x5
    v_min_u32_dpp v152, v148, v148 row_shr:4 row_mask:0xf bank_mask:0xa
    v_mov_b32 v148, v152
    s_nop 1
    v_mov_b32_dpp v152, v148 quad_perm:[2,3,0,1] row_mask:0xf bank_mask:0xf
    v_med3_u32 v148, v148, v152, v43
    s_nop 1
    v_mov_b32_dpp v152, v148 quad_perm:[1,0,3,2] row_mask:0xf bank_mask:0xf
    v_med3_u32 v148, v148, v152, v42
    v_mov_b32 v152, v148
    s_nop 1
    v_permlane16_swap_b32 v148, v152
    s_nop 1
    v_max_u32_dpp v148, v152, v148 row_half_mirror row_mask:0xf bank_mask:0xf
    s_nop 1
    v_max_u32_dpp v152, v148, v148 row_shl:4 row_mask:0xf bank_mask:0x5
    v_min_u32_dpp v152, v148, v148 row_shr:4 row_mask:0xf bank_mask:0xa
    v_mov_b32 v148, v152
    s_nop 1
    v_mov_b32_dpp v152, v148 quad_perm:[2,3,0,1] row_mask:0xf bank_mask:0xf
    v_med3_u32 v148, v148, v152, v43
    s_nop 1
    v_mov_b32_dpp v152, v148 quad_perm:[1,0,3,2] row_mask:0xf bank_mask:0xf
    v_med3_u32 v148, v148, v152, v42
    v_mov_b32 v152, v148
    s_nop 1
    v_permlane32_swap_b32 v148, v152
    s_nop 1
    v_max_u32_dpp v148, v152, v148 row_half_mirror row_mask:0xf bank_mask:0xf
    s_nop 1
    v_max_u32_dpp v152, v148, v148 row_shl:4 row_mask:0xf bank_mask:0x5
    v_min_u32_dpp v152, v148, v148 row_shr:4 row_mask:0xf bank_mask:0xa
    v_mov_b32 v148, v152
    s_nop 1
    v_mov_b32_dpp v152, v148 quad_perm:[2,3,0,1] row_mask:0xf bank_mask:0xf
    v_med3_u32 v148, v148, v152, v43
    s_nop 1
    v_mov_b32_dpp v152, v148 quad_perm:[1,0,3,2] row_mask:0xf bank_mask:0xf
    v_med3_u32 v148, v148, v152, v42
    s_mov_b64 exec, 0xff
    ds_write_b32 v45, v148
    s_mov_b64 exec, -1
    s_waitcnt lgkmcnt(0)
    s_barrier
    ds_read_b32 v148, v46
    s_waitcnt lgkmcnt(0)
    v_max_u32_dpp v148, v148, v148 row_mirror row_mask:0xf bank_mask:0xf
    s_nop 1
    v_max_u32_dpp v152, v148, v148 row_shl:4 row_mask:0xf bank_mask:0x5
    v_min_u32_dpp v152, v148, v148 row_shr:4 row_mask:0xf bank_mask:0xa
    v_mov_b32 v148, v152
    s_nop 1
    v_mov_b32_dpp v152, v148 quad_perm:[2,3,0,1] row_mask:0xf bank_mask:0xf
    v_med3_u32 v148, v148, v152, v43
    s_nop 1
    v_mov_b32_dpp v152, v148 quad_perm:[1,0,3,2] row_mask:0xf bank_mask:0xf
    v_med3_u32 v148, v148, v152, v42
    v_mov_b32 v152, v148
    s_nop 1
    v_permlane16_swap_b32 v148, v152
    s_nop 1
    v_max_u32_dpp v148, v152, v148 row_half_mirror row_mask:0xf bank_mask:0xf
    s_nop 1
    v_max_u32_dpp v152, v148, v148 row_shl:4 row_mask:0xf bank_mask:0x5
    v_min_u32_dpp v152, v148, v148 row_shr:4 row_mask:0xf bank_mask:0xa
    v_mov_b32 v148, v152
    s_nop 1
    v_mov_b32_dpp v152, v148 quad_perm:[2,3,0,1] row_mask:0xf bank_mask:0xf
    v_med3_u32 v148, v148, v152, v43
    s_nop 1
    v_mov_b32_dpp v152, v148 quad_perm:[1,0,3,2] row_mask:0xf bank_mask:0xf
    v_med3_u32 v148, v148, v152, v42
    v_mov_b32 v152, v148
    s_nop 1
    v_permlane32_swap_b32 v148, v152
    s_nop 1
    v_max_u32_dpp v148, v152, v148 row_half_mirror row_mask:0xf bank_mask:0xf
    s_nop 1
    v_max_u32_dpp v152, v148, v148 row_shl:4 row_mask:0xf bank_mask:0x5
    v_min_u32_dpp v152, v148, v148 row_shr:4 row_mask:0xf bank_mask:0xa
    v_mov_b32 v148, v152
    s_nop 1
    v_mov_b32_dpp v152, v148 quad_perm:[2,3,0,1] row_mask:0xf bank_mask:0xf
    v_med3_u32 v148, v148, v152, v43
    s_nop 1
    v_mov_b32_dpp v152, v148 quad_perm:[1,0,3,2] row_mask:0xf bank_mask:0xf
    v_med3_u32 v148, v148, v152, v42
    s_branch Lseldone
.section .rodata,"a"
.p2align 6
.amdhsa_kernel sequential_preLN__spectral_fnet__moe_arch_mod__prompt_kernel
  .amdhsa_next_free_vgpr 248
  .amdhsa_next_free_sgpr 102
  .amdhsa_accum_offset 248
  .amdhsa_group_segment_fixed_size 0
  .amdhsa_kernarg_size 104
  .amdhsa_user_sgpr_count 2
  .amdhsa_user_sgpr_kernarg_segment_ptr 1
  .amdhsa_system_sgpr_workgroup_id_x 1
.end_amdhsa_kernel
```
